```python
import torch

def _softmax(x, axis=-1):
    return torch.softmax(x, dim=axis)

def _gelu(x):
    return torch.nn.functional.gelu(x, approximate='tanh')

def _silu(x):
    return torch.nn.functional.silu(x)

def _sigmoid(x):
    return torch.sigmoid(x)

def _layernorm(x, axis=-1, eps=1e-05):
    m = x.mean(dim=axis, keepdim=True)
    v = x.var(dim=axis, keepdim=True, unbiased=False)
    return (x - m) / torch.sqrt(v + eps)

def _scatter_add(tgt, idx, src, axis=0):
    return tgt.clone().index_add_(axis, idx, src)

def _segment_sum(src, seg, n):
    out = torch.zeros((n,) + src.shape[1:], dtype=src.dtype)
    return out.index_add_(0, seg, src)

def _pad(x, pw):
    flat = tuple((v for pair in reversed(pw) for v in pair))
    return torch.nn.functional.pad(x, flat)
kernel_name = 'adaLN_cond__mha_block_cached__dense_activation_silu__decode'

def setup_inputs():

    _w = lambda a: (lambda t: t.to(torch.bfloat16) if t.is_floating_point() else t)(torch.as_tensor(a))

    def _A_setup():
        B, Sq, D = (8, 1, 640)
        H, Sk, Dh = (32, 4096, 128)
        return {'x': _w((lambda *s: torch.randn(*s, dtype=torch.bfloat16) * 0.1)(B, Sq, D)), 'k_cache': _w((lambda *s: torch.randn(*s, dtype=torch.bfloat16) * 0.8)(B, H, Sk, Dh)), 'v_cache': _w((lambda *s: torch.randn(*s, dtype=torch.bfloat16) * 3.2)(B, H, Sk, Dh)), 'wq': _w((lambda *s: torch.randn(*s, dtype=torch.bfloat16) * 0.8)(D, H * Dh) * D ** (-0.5)), 'wo': _w((lambda *s: torch.randn(*s, dtype=torch.bfloat16) * 3.2)(H * Dh, D) * (H * Dh) ** (-0.5))}
    _A_in = _A_setup()

    def _B_setup():
        B, S, D, F = (8, 1, 640, 1728)
        return {'x': _w((lambda *s: torch.randn(*s, dtype=torch.bfloat16) * 0.1)(B, S, D)), 'w1': _w((lambda *s: torch.randn(*s, dtype=torch.bfloat16) * 3.2)(D, F) * D ** (-0.5)), 'w2': _w((lambda *s: torch.randn(*s, dtype=torch.bfloat16) * 3.2)(F, D) * F ** (-0.5))}
    _B_in = _B_setup()
    return {'A_x': _A_in['x'], 'A_k_cache': _A_in['k_cache'], 'A_v_cache': _A_in['v_cache'], 'A_wq': _A_in['wq'], 'A_wo': _A_in['wo'], 'B_x': _B_in['x'], 'B_w1': _B_in['w1'], 'B_w2': _B_in['w2'], 'c': _w((lambda *s: torch.randn(*s, dtype=torch.bfloat16) * 0.2)(8, 640) * 8.0), 'w_mod': _w((lambda *s: torch.randn(*s, dtype=torch.bfloat16) * 0.2)(640, 6 * 640) * 640 ** (-0.5) * 8.0)}

def reference(A_x, A_k_cache, A_v_cache, A_wq, A_wo, B_x, B_w1, B_w2, c, w_mod):

    def _A_ref(x, k_cache, v_cache, wq, wo):
        B, Sq, D = x.shape
        H, Dh = (32, 128)
        q = (lambda x, *d: x.permute(*d))((x @ wq).reshape(B, Sq, H, Dh), 0, 2, 1, 3)
        scores = torch.einsum('bhqd,bhkd->bhqk', q, k_cache) * Dh ** (-0.5)
        p = _softmax(scores, axis=-1)
        o = torch.einsum('bhqk,bhkd->bhqd', p, v_cache)
        return (lambda x, *d: x.permute(*d))(o, 0, 2, 1, 3).reshape(B, Sq, H * Dh) @ wo

    def _B_ref(x, w1, w2):
        h = torch.einsum('bsd,df->bsf', x, w1)
        h = _silu(h)
        out = torch.einsum('bsf,fd->bsd', h, w2)
        return out
    x = A_x
    mod = (_silu(c) @ w_mod).reshape(c.shape[0], 6, 1, -1)
    sa, ca, ga, sb, cb, gb = (mod[:, 0].clone(), mod[:, 1].clone(), mod[:, 2].clone(), mod[:, 3].clone(), mod[:, 4].clone(), mod[:, 5].clone())
    h = _layernorm(x, axis=-1) * (1 + ca) + sa
    x = x + ga * _A_ref(h, A_k_cache, A_v_cache, A_wq, A_wo)
    h = _layernorm(x, axis=-1) * (1 + cb) + sb
    x = x + gb * _B_ref(h, B_w1, B_w2)
    return x
```

```asm
; @launch grid=(256,1,1) block=(768,1,1) lds=155648
.amdgcn_target "amdgcn-amd-amdhsa--gfx950"
.text
.globl adaLN_cond__mha_block_cached__dense_activation_silu__decode_kernel
.p2align 8
.type adaLN_cond__mha_block_cached__dense_activation_silu__decode_kernel,@function
adaLN_cond__mha_block_cached__dense_activation_silu__decode_kernel:
  s_cmp_ge_u32 s2, 256
  s_cbranch_scc1 L_EXIT
  s_load_dwordx16 s[8:23], s[0:1], 0
  s_load_dwordx4 s[24:27], s[0:1], 64
  s_load_dwordx2 s[28:29], s[0:1], 80
  s_load_dwordx4 s[4:7], s[0:1], 88
  v_lshrrev_b32 v1, 6, v0
  v_and_b32 v0, 63, v0
  v_readfirstlane_b32 s3, v1
  s_lshr_b32 s34, s2, 5
  s_and_b32 s35, s2, 31
  s_mov_b32 s78, s2
  v_lshrrev_b32 v1, 4, v0
  v_and_b32 v2, 15, v0
  s_mov_b32 s79, s3
  s_cmp_ge_u32 s3, 4
  s_cbranch_scc1 L_STREAM
  s_setprio 3
  v_and_b32 v3, 7, v2
  v_mov_b32 v4, 0
  v_mov_b32 v5, 0
  s_mov_b32 s60, 0x05040100
  s_mov_b32 s61, 0x07060302
  s_mov_b32 s30, 0
  s_mov_b32 s31, 0
  s_cmp_lg_u32 s3, 1
  s_cbranch_scc1 Lq0_1
  v_mov_b32 v6, 0
  ds_write_b32 v6, v6 offset:16664
  s_waitcnt lgkmcnt(0)
Lq0_1:
  s_waitcnt lgkmcnt(0)
  s_barrier
  s_mov_b32 s36, s6
  s_mov_b32 s37, s7
  s_mov_b32 s38, 1048576
  s_mov_b32 s39, 0x20000
  s_mov_b32 s40, s4
  s_mov_b32 s41, s5
  s_mov_b32 s42, 256
  s_mov_b32 s43, 0x20000
  s_cmp_lg_u32 s2, 255
  s_cbranch_scc1 Lr_2
  s_cmp_lg_u32 s3, 3
  s_cbranch_scc1 Lr_2
  s_memrealtime s[58:59]
  s_waitcnt lgkmcnt(0)
  s_or_b32 s58, s58, 1
  v_mov_b32 v8, s58
  v_mov_b32 v9, 0
  buffer_store_dword v8, v9, s[40:43], 0 offen sc1
Lr_2:
  s_cmp_ge_u32 s2, 231
  s_cbranch_scc1 L_P1C_A
  s_cmp_ge_u32 s2, 119
  s_cbranch_scc1 L_PNONE
  s_cmp_ge_u32 s2, 104
  s_cbranch_scc1 L_P1C_B
  s_cmp_ge_u32 s2, 40
  s_cbranch_scc1 L_P2
  s_add_u32 s69, s2, 20
  s_mov_b32 s48, s24
  s_mov_b32 s49, s25
  s_mov_b32 s50, 10240
  s_mov_b32 s51, 0x20000
  s_lshl_b32 s56, s69, 7
  s_add_u32 s44, s26, s56
  s_addc_u32 s45, s27, 0
  s_sub_u32 s46, 4915200, s56
  s_mov_b32 s47, 0x20000
  v_lshrrev_b32 v7, 3, v2
  v_lshlrev_b32 v7, 6, v7
  v_lshl_add_u32 v7, v1, 4, v7
  s_movk_i32 s57, 1280
  v_mul_lo_u32 v6, v3, s57
  v_add_u32 v6, v6, v7
  s_lshl_b32 s56, s3, 7
  buffer_load_dwordx4 v[8:11], v6, s[48:51], s56 offen offset:0
  buffer_load_dwordx4 v[12:15], v6, s[48:51], s56 offen offset:512
  buffer_load_dwordx4 v[16:19], v6, s[48:51], s56 offen offset:1024
  s_mov_b32 s57, 61440
  v_mul_lo_u32 v5, v1, s57
  v_lshl_add_u32 v5, v2, 3, v5
  s_add_u32 s56, s3, 0
  s_mul_i32 s56, s56, 491520
  buffer_load_dwordx2 v[52:53], v5, s[44:47], s56 offen nt
  s_add_u32 s56, s56, 7680
  buffer_load_dwordx2 v[54:55], v5, s[44:47], s56 offen nt
  s_add_u32 s56, s56, 7680
  buffer_load_dwordx2 v[56:57], v5, s[44:47], s56 offen nt
  s_add_u32 s56, s56, 7680
  buffer_load_dwordx2 v[58:59], v5, s[44:47], s56 offen nt
  s_add_u32 s56, s56, 7680
  buffer_load_dwordx2 v[60:61], v5, s[44:47], s56 offen nt
  s_add_u32 s56, s56, 7680
  buffer_load_dwordx2 v[62:63], v5, s[44:47], s56 offen nt
  s_add_u32 s56, s56, 7680
  buffer_load_dwordx2 v[64:65], v5, s[44:47], s56 offen nt
  s_add_u32 s56, s56, 7680
  buffer_load_dwordx2 v[66:67], v5, s[44:47], s56 offen nt
  s_add_u32 s56, s56, 192000
  buffer_load_dwordx2 v[68:69], v5, s[44:47], s56 offen nt
  s_add_u32 s56, s56, 7680
  buffer_load_dwordx2 v[70:71], v5, s[44:47], s56 offen nt
  s_add_u32 s56, s56, 7680
  buffer_load_dwordx2 v[72:73], v5, s[44:47], s56 offen nt
  s_add_u32 s56, s56, 7680
  buffer_load_dwordx2 v[74:75], v5, s[44:47], s56 offen nt
  s_add_u32 s56, s56, 7680
  buffer_load_dwordx2 v[76:77], v5, s[44:47], s56 offen nt
  s_add_u32 s56, s56, 7680
  buffer_load_dwordx2 v[78:79], v5, s[44:47], s56 offen nt
  s_add_u32 s56, s56, 7680
  buffer_load_dwordx2 v[80:81], v5, s[44:47], s56 offen nt
  s_add_u32 s56, s56, 7680
  buffer_load_dwordx2 v[82:83], v5, s[44:47], s56 offen nt
  s_add_u32 s56, s3, 4
  s_mul_i32 s56, s56, 491520
  buffer_load_dwordx2 v[84:85], v5, s[44:47], s56 offen nt
  s_add_u32 s56, s56, 7680
  buffer_load_dwordx2 v[86:87], v5, s[44:47], s56 offen nt
  s_add_u32 s56, s56, 7680
  buffer_load_dwordx2 v[88:89], v5, s[44:47], s56 offen nt
  s_add_u32 s56, s56, 7680
  buffer_load_dwordx2 v[90:91], v5, s[44:47], s56 offen nt
  s_add_u32 s56, s56, 7680
  buffer_load_dwordx2 v[92:93], v5, s[44:47], s56 offen nt
  s_add_u32 s56, s56, 7680
  buffer_load_dwordx2 v[94:95], v5, s[44:47], s56 offen nt
  s_add_u32 s56, s56, 7680
  buffer_load_dwordx2 v[96:97], v5, s[44:47], s56 offen nt
  s_add_u32 s56, s56, 7680
  buffer_load_dwordx2 v[98:99], v5, s[44:47], s56 offen nt
  s_add_u32 s56, s56, 192000
  buffer_load_dwordx2 v[100:101], v5, s[44:47], s56 offen nt
  s_add_u32 s56, s56, 7680
  buffer_load_dwordx2 v[102:103], v5, s[44:47], s56 offen nt
  s_add_u32 s56, s56, 7680
  buffer_load_dwordx2 v[104:105], v5, s[44:47], s56 offen nt
  s_add_u32 s56, s56, 7680
  buffer_load_dwordx2 v[106:107], v5, s[44:47], s56 offen nt
  s_add_u32 s56, s56, 7680
  buffer_load_dwordx2 v[108:109], v5, s[44:47], s56 offen nt
  s_add_u32 s56, s56, 7680
  buffer_load_dwordx2 v[110:111], v5, s[44:47], s56 offen nt
  s_add_u32 s56, s56, 7680
  buffer_load_dwordx2 v[112:113], v5, s[44:47], s56 offen nt
  s_add_u32 s56, s56, 7680
  buffer_load_dwordx2 v[114:115], v5, s[44:47], s56 offen nt
  s_cmp_ge_u32 s3, 2
  s_cbranch_scc1 Lskw_3
  s_add_u32 s56, s3, 8
  s_mul_i32 s56, s56, 491520
  buffer_load_dwordx2 v[116:117], v5, s[44:47], s56 offen nt
  s_add_u32 s56, s56, 7680
  buffer_load_dwordx2 v[118:119], v5, s[44:47], s56 offen nt
  s_add_u32 s56, s56, 7680
  buffer_load_dwordx2 v[120:121], v5, s[44:47], s56 offen nt
  s_add_u32 s56, s56, 7680
  buffer_load_dwordx2 v[122:123], v5, s[44:47], s56 offen nt
  s_add_u32 s56, s56, 7680
  buffer_load_dwordx2 v[124:125], v5, s[44:47], s56 offen nt
  s_add_u32 s56, s56, 7680
  buffer_load_dwordx2 v[126:127], v5, s[44:47], s56 offen nt
  s_add_u32 s56, s56, 7680
  buffer_load_dwordx2 v[128:129], v5, s[44:47], s56 offen nt
  s_add_u32 s56, s56, 7680
  buffer_load_dwordx2 v[130:131], v5, s[44:47], s56 offen nt
  s_add_u32 s56, s56, 192000
  buffer_load_dwordx2 v[132:133], v5, s[44:47], s56 offen nt
  s_add_u32 s56, s56, 7680
  buffer_load_dwordx2 v[134:135], v5, s[44:47], s56 offen nt
  s_add_u32 s56, s56, 7680
  buffer_load_dwordx2 v[136:137], v5, s[44:47], s56 offen nt
  s_add_u32 s56, s56, 7680
  buffer_load_dwordx2 v[138:139], v5, s[44:47], s56 offen nt
  s_add_u32 s56, s56, 7680
  buffer_load_dwordx2 v[140:141], v5, s[44:47], s56 offen nt
  s_add_u32 s56, s56, 7680
  buffer_load_dwordx2 v[142:143], v5, s[44:47], s56 offen nt
  s_add_u32 s56, s56, 7680
  buffer_load_dwordx2 v[144:145], v5, s[44:47], s56 offen nt
  s_add_u32 s56, s56, 7680
  buffer_load_dwordx2 v[146:147], v5, s[44:47], s56 offen nt
Lskw_3:
  v_mov_b32 v7, 0
  buffer_load_dword v4, v7, s[40:43], 0 offen sc1
  s_cmp_ge_u32 s3, 2
  s_cbranch_scc1 Lw_4
  s_waitcnt vmcnt(49)
  s_branch Lw_5
Lw_4:
  s_waitcnt vmcnt(33)
Lw_5:
  v_lshlrev_b32 v164, 16, v8
  v_and_b32 v165, 0xffff0000, v8
  v_mul_f32 v166, 0xbfb8aa3b, v164
  v_mul_f32 v167, 0xbfb8aa3b, v165
  v_exp_f32 v166, v166
  v_exp_f32 v167, v167
  s_nop 0
  v_add_f32 v166, 1.0, v166
  v_add_f32 v167, 1.0, v167
  v_rcp_f32 v166, v166
  v_rcp_f32 v167, v167
  s_nop 0
  v_mul_f32 v164, v164, v166
  v_mul_f32 v165, v165, v167
  v_cvt_pk_bf16_f32 v8, v164, v165
  v_lshlrev_b32 v164, 16, v9
  v_and_b32 v165, 0xffff0000, v9
  v_mul_f32 v166, 0xbfb8aa3b, v164
  v_mul_f32 v167, 0xbfb8aa3b, v165
  v_exp_f32 v166, v166
  v_exp_f32 v167, v167
  s_nop 0
  v_add_f32 v166, 1.0, v166
  v_add_f32 v167, 1.0, v167
  v_rcp_f32 v166, v166
  v_rcp_f32 v167, v167
  s_nop 0
  v_mul_f32 v164, v164, v166
  v_mul_f32 v165, v165, v167
  v_cvt_pk_bf16_f32 v9, v164, v165
  v_lshlrev_b32 v164, 16, v10
  v_and_b32 v165, 0xffff0000, v10
  v_mul_f32 v166, 0xbfb8aa3b, v164
  v_mul_f32 v167, 0xbfb8aa3b, v165
  v_exp_f32 v166, v166
  v_exp_f32 v167, v167
  s_nop 0
  v_add_f32 v166, 1.0, v166
  v_add_f32 v167, 1.0, v167
  v_rcp_f32 v166, v166
  v_rcp_f32 v167, v167
  s_nop 0
  v_mul_f32 v164, v164, v166
  v_mul_f32 v165, v165, v167
  v_cvt_pk_bf16_f32 v10, v164, v165
  v_lshlrev_b32 v164, 16, v11
  v_and_b32 v165, 0xffff0000, v11
  v_mul_f32 v166, 0xbfb8aa3b, v164
  v_mul_f32 v167, 0xbfb8aa3b, v165
  v_exp_f32 v166, v166
  v_exp_f32 v167, v167
  s_nop 0
  v_add_f32 v166, 1.0, v166
  v_add_f32 v167, 1.0, v167
  v_rcp_f32 v166, v166
  v_rcp_f32 v167, v167
  s_nop 0
  v_mul_f32 v164, v164, v166
  v_mul_f32 v165, v165, v167
  v_cvt_pk_bf16_f32 v11, v164, v165
  v_lshlrev_b32 v164, 16, v12
  v_and_b32 v165, 0xffff0000, v12
  v_mul_f32 v166, 0xbfb8aa3b, v164
  v_mul_f32 v167, 0xbfb8aa3b, v165
  v_exp_f32 v166, v166
  v_exp_f32 v167, v167
  s_nop 0
  v_add_f32 v166, 1.0, v166
  v_add_f32 v167, 1.0, v167
  v_rcp_f32 v166, v166
  v_rcp_f32 v167, v167
  s_nop 0
  v_mul_f32 v164, v164, v166
  v_mul_f32 v165, v165, v167
  v_cvt_pk_bf16_f32 v12, v164, v165
  v_lshlrev_b32 v164, 16, v13
  v_and_b32 v165, 0xffff0000, v13
  v_mul_f32 v166, 0xbfb8aa3b, v164
  v_mul_f32 v167, 0xbfb8aa3b, v165
  v_exp_f32 v166, v166
  v_exp_f32 v167, v167
  s_nop 0
  v_add_f32 v166, 1.0, v166
  v_add_f32 v167, 1.0, v167
  v_rcp_f32 v166, v166
  v_rcp_f32 v167, v167
  s_nop 0
  v_mul_f32 v164, v164, v166
  v_mul_f32 v165, v165, v167
  v_cvt_pk_bf16_f32 v13, v164, v165
  v_lshlrev_b32 v164, 16, v14
  v_and_b32 v165, 0xffff0000, v14
  v_mul_f32 v166, 0xbfb8aa3b, v164
  v_mul_f32 v167, 0xbfb8aa3b, v165
  v_exp_f32 v166, v166
  v_exp_f32 v167, v167
  s_nop 0
  v_add_f32 v166, 1.0, v166
  v_add_f32 v167, 1.0, v167
  v_rcp_f32 v166, v166
  v_rcp_f32 v167, v167
  s_nop 0
  v_mul_f32 v164, v164, v166
  v_mul_f32 v165, v165, v167
  v_cvt_pk_bf16_f32 v14, v164, v165
  v_lshlrev_b32 v164, 16, v15
  v_and_b32 v165, 0xffff0000, v15
  v_mul_f32 v166, 0xbfb8aa3b, v164
  v_mul_f32 v167, 0xbfb8aa3b, v165
  v_exp_f32 v166, v166
  v_exp_f32 v167, v167
  s_nop 0
  v_add_f32 v166, 1.0, v166
  v_add_f32 v167, 1.0, v167
  v_rcp_f32 v166, v166
  v_rcp_f32 v167, v167
  s_nop 0
  v_mul_f32 v164, v164, v166
  v_mul_f32 v165, v165, v167
  v_cvt_pk_bf16_f32 v15, v164, v165
  s_cmp_ge_u32 s3, 2
  s_cbranch_scc1 Lsk3_6
  v_lshlrev_b32 v164, 16, v16
  v_and_b32 v165, 0xffff0000, v16
  v_mul_f32 v166, 0xbfb8aa3b, v164
  v_mul_f32 v167, 0xbfb8aa3b, v165
  v_exp_f32 v166, v166
  v_exp_f32 v167, v167
  s_nop 0
  v_add_f32 v166, 1.0, v166
  v_add_f32 v167, 1.0, v167
  v_rcp_f32 v166, v166
  v_rcp_f32 v167, v167
  s_nop 0
  v_mul_f32 v164, v164, v166
  v_mul_f32 v165, v165, v167
  v_cvt_pk_bf16_f32 v16, v164, v165
  v_lshlrev_b32 v164, 16, v17
  v_and_b32 v165, 0xffff0000, v17
  v_mul_f32 v166, 0xbfb8aa3b, v164
  v_mul_f32 v167, 0xbfb8aa3b, v165
  v_exp_f32 v166, v166
  v_exp_f32 v167, v167
  s_nop 0
  v_add_f32 v166, 1.0, v166
  v_add_f32 v167, 1.0, v167
  v_rcp_f32 v166, v166
  v_rcp_f32 v167, v167
  s_nop 0
  v_mul_f32 v164, v164, v166
  v_mul_f32 v165, v165, v167
  v_cvt_pk_bf16_f32 v17, v164, v165
  v_lshlrev_b32 v164, 16, v18
  v_and_b32 v165, 0xffff0000, v18
  v_mul_f32 v166, 0xbfb8aa3b, v164
  v_mul_f32 v167, 0xbfb8aa3b, v165
  v_exp_f32 v166, v166
  v_exp_f32 v167, v167
  s_nop 0
  v_add_f32 v166, 1.0, v166
  v_add_f32 v167, 1.0, v167
  v_rcp_f32 v166, v166
  v_rcp_f32 v167, v167
  s_nop 0
  v_mul_f32 v164, v164, v166
  v_mul_f32 v165, v165, v167
  v_cvt_pk_bf16_f32 v18, v164, v165
  v_lshlrev_b32 v164, 16, v19
  v_and_b32 v165, 0xffff0000, v19
  v_mul_f32 v166, 0xbfb8aa3b, v164
  v_mul_f32 v167, 0xbfb8aa3b, v165
  v_exp_f32 v166, v166
  v_exp_f32 v167, v167
  s_nop 0
  v_add_f32 v166, 1.0, v166
  v_add_f32 v167, 1.0, v167
  v_rcp_f32 v166, v166
  v_rcp_f32 v167, v167
  s_nop 0
  v_mul_f32 v164, v164, v166
  v_mul_f32 v165, v165, v167
  v_cvt_pk_bf16_f32 v19, v164, v165
Lsk3_6:
  s_waitcnt vmcnt(0)
  v_perm_b32 v148, v54, v52, s60
  v_perm_b32 v152, v54, v52, s61
  v_perm_b32 v156, v55, v53, s60
  v_perm_b32 v160, v55, v53, s61
  v_perm_b32 v149, v58, v56, s60
  v_perm_b32 v153, v58, v56, s61
  v_perm_b32 v157, v59, v57, s60
  v_perm_b32 v161, v59, v57, s61
  v_perm_b32 v150, v62, v60, s60
  v_perm_b32 v154, v62, v60, s61
  v_perm_b32 v158, v63, v61, s60
  v_perm_b32 v162, v63, v61, s61
  v_perm_b32 v151, v66, v64, s60
  v_perm_b32 v155, v66, v64, s61
  v_perm_b32 v159, v67, v65, s60
  v_perm_b32 v163, v67, v65, s61
  s_nop 1
  v_mfma_f32_16x16x32_bf16 v[20:23], v[8:11], v[148:151], 0
  v_mfma_f32_16x16x32_bf16 v[24:27], v[8:11], v[152:155], 0
  v_mfma_f32_16x16x32_bf16 v[28:31], v[8:11], v[156:159], 0
  v_mfma_f32_16x16x32_bf16 v[32:35], v[8:11], v[160:163], 0
  v_perm_b32 v148, v70, v68, s60
  v_perm_b32 v152, v70, v68, s61
  v_perm_b32 v156, v71, v69, s60
  v_perm_b32 v160, v71, v69, s61
  v_perm_b32 v149, v74, v72, s60
  v_perm_b32 v153, v74, v72, s61
  v_perm_b32 v157, v75, v73, s60
  v_perm_b32 v161, v75, v73, s61
  v_perm_b32 v150, v78, v76, s60
  v_perm_b32 v154, v78, v76, s61
  v_perm_b32 v158, v79, v77, s60
  v_perm_b32 v162, v79, v77, s61
  v_perm_b32 v151, v82, v80, s60
  v_perm_b32 v155, v82, v80, s61
  v_perm_b32 v159, v83, v81, s60
  v_perm_b32 v163, v83, v81, s61
  s_nop 1
  v_mfma_f32_16x16x32_bf16 v[36:39], v[8:11], v[148:151], 0
  v_mfma_f32_16x16x32_bf16 v[40:43], v[8:11], v[152:155], 0
  v_mfma_f32_16x16x32_bf16 v[44:47], v[8:11], v[156:159], 0
  v_mfma_f32_16x16x32_bf16 v[48:51], v[8:11], v[160:163], 0
  v_perm_b32 v148, v86, v84, s60
  v_perm_b32 v152, v86, v84, s61
  v_perm_b32 v156, v87, v85, s60
  v_perm_b32 v160, v87, v85, s61
  v_perm_b32 v149, v90, v88, s60
  v_perm_b32 v153, v90, v88, s61
  v_perm_b32 v157, v91, v89, s60
  v_perm_b32 v161, v91, v89, s61
  v_perm_b32 v150, v94, v92, s60
  v_perm_b32 v154, v94, v92, s61
  v_perm_b32 v158, v95, v93, s60
  v_perm_b32 v162, v95, v93, s61
  v_perm_b32 v151, v98, v96, s60
  v_perm_b32 v155, v98, v96, s61
  v_perm_b32 v159, v99, v97, s60
  v_perm_b32 v163, v99, v97, s61
  s_nop 1
  v_mfma_f32_16x16x32_bf16 v[20:23], v[12:15], v[148:151], v[20:23]
  v_mfma_f32_16x16x32_bf16 v[24:27], v[12:15], v[152:155], v[24:27]
  v_mfma_f32_16x16x32_bf16 v[28:31], v[12:15], v[156:159], v[28:31]
  v_mfma_f32_16x16x32_bf16 v[32:35], v[12:15], v[160:163], v[32:35]
  v_perm_b32 v148, v102, v100, s60
  v_perm_b32 v152, v102, v100, s61
  v_perm_b32 v156, v103, v101, s60
  v_perm_b32 v160, v103, v101, s61
  v_perm_b32 v149, v106, v104, s60
  v_perm_b32 v153, v106, v104, s61
  v_perm_b32 v157, v107, v105, s60
  v_perm_b32 v161, v107, v105, s61
  v_perm_b32 v150, v110, v108, s60
  v_perm_b32 v154, v110, v108, s61
  v_perm_b32 v158, v111, v109, s60
  v_perm_b32 v162, v111, v109, s61
  v_perm_b32 v151, v114, v112, s60
  v_perm_b32 v155, v114, v112, s61
  v_perm_b32 v159, v115, v113, s60
  v_perm_b32 v163, v115, v113, s61
  s_nop 1
  v_mfma_f32_16x16x32_bf16 v[36:39], v[12:15], v[148:151], v[36:39]
  v_mfma_f32_16x16x32_bf16 v[40:43], v[12:15], v[152:155], v[40:43]
  v_mfma_f32_16x16x32_bf16 v[44:47], v[12:15], v[156:159], v[44:47]
  v_mfma_f32_16x16x32_bf16 v[48:51], v[12:15], v[160:163], v[48:51]
  s_cmp_ge_u32 s3, 2
  s_cbranch_scc1 Lsk3_7
  v_perm_b32 v148, v118, v116, s60
  v_perm_b32 v152, v118, v116, s61
  v_perm_b32 v156, v119, v117, s60
  v_perm_b32 v160, v119, v117, s61
  v_perm_b32 v149, v122, v120, s60
  v_perm_b32 v153, v122, v120, s61
  v_perm_b32 v157, v123, v121, s60
  v_perm_b32 v161, v123, v121, s61
  v_perm_b32 v150, v126, v124, s60
  v_perm_b32 v154, v126, v124, s61
  v_perm_b32 v158, v127, v125, s60
  v_perm_b32 v162, v127, v125, s61
  v_perm_b32 v151, v130, v128, s60
  v_perm_b32 v155, v130, v128, s61
  v_perm_b32 v159, v131, v129, s60
  v_perm_b32 v163, v131, v129, s61
  s_nop 1
  v_mfma_f32_16x16x32_bf16 v[20:23], v[16:19], v[148:151], v[20:23]
  v_mfma_f32_16x16x32_bf16 v[24:27], v[16:19], v[152:155], v[24:27]
  v_mfma_f32_16x16x32_bf16 v[28:31], v[16:19], v[156:159], v[28:31]
  v_mfma_f32_16x16x32_bf16 v[32:35], v[16:19], v[160:163], v[32:35]
  v_perm_b32 v148, v134, v132, s60
  v_perm_b32 v152, v134, v132, s61
  v_perm_b32 v156, v135, v133, s60
  v_perm_b32 v160, v135, v133, s61
  v_perm_b32 v149, v138, v136, s60
  v_perm_b32 v153, v138, v136, s61
  v_perm_b32 v157, v139, v137, s60
  v_perm_b32 v161, v139, v137, s61
  v_perm_b32 v150, v142, v140, s60
  v_perm_b32 v154, v142, v140, s61
  v_perm_b32 v158, v143, v141, s60
  v_perm_b32 v162, v143, v141, s61
  v_perm_b32 v151, v146, v144, s60
  v_perm_b32 v155, v146, v144, s61
  v_perm_b32 v159, v147, v145, s60
  v_perm_b32 v163, v147, v145, s61
  s_nop 1
  v_mfma_f32_16x16x32_bf16 v[36:39], v[16:19], v[148:151], v[36:39]
  v_mfma_f32_16x16x32_bf16 v[40:43], v[16:19], v[152:155], v[40:43]
  v_mfma_f32_16x16x32_bf16 v[44:47], v[16:19], v[156:159], v[44:47]
  v_mfma_f32_16x16x32_bf16 v[48:51], v[16:19], v[160:163], v[48:51]
Lsk3_7:
  v_readfirstlane_b32 s31, v4
  v_lshrrev_b32 v6, 1, v1
  v_lshlrev_b32 v6, 11, v6
  v_and_b32 v7, 1, v1
  v_lshl_add_u32 v6, v7, 10, v6
  v_lshl_add_u32 v6, v2, 4, v6
  s_lshl_b32 s56, s3, 12
  v_add_u32 v6, s56, v6
  s_mov_b32 s58, 0
  s_mov_b32 s59, -1
  s_nop 2
  v_cndmask_b32 v52, v20, v36, s[58:59]
  v_cndmask_b32 v53, v24, v40, s[58:59]
  v_cndmask_b32 v54, v28, v44, s[58:59]
  v_cndmask_b32 v55, v32, v48, s[58:59]
  v_cndmask_b32 v56, v21, v37, s[58:59]
  v_cndmask_b32 v57, v25, v41, s[58:59]
  v_cndmask_b32 v58, v29, v45, s[58:59]
  v_cndmask_b32 v59, v33, v49, s[58:59]
  v_cndmask_b32 v60, v22, v38, s[58:59]
  v_cndmask_b32 v61, v26, v42, s[58:59]
  v_cndmask_b32 v62, v30, v46, s[58:59]
  v_cndmask_b32 v63, v34, v50, s[58:59]
  v_cndmask_b32 v64, v23, v39, s[58:59]
  v_cndmask_b32 v65, v27, v43, s[58:59]
  v_cndmask_b32 v66, v31, v47, s[58:59]
  v_cndmask_b32 v67, v35, v51, s[58:59]
  ds_write_b128 v6, v[52:55] offset:0
  ds_write_b128 v6, v[56:59] offset:256
  ds_write_b128 v6, v[60:63] offset:512
  ds_write_b128 v6, v[64:67] offset:768
  s_waitcnt lgkmcnt(0)
  s_cmp_lg_u32 s31, 0
  s_cbranch_scc1 Lgn_8
  v_mov_b32 v165, 0
Lpoll_9:
  buffer_load_dword v164, v165, s[40:43], 0 offen sc1
  s_waitcnt vmcnt(0)
  v_cmp_eq_u32 vcc, 0, v164
  s_cbranch_vccz Lpd_10
  s_sleep 1
  s_add_u32 s30, s30, 1
  s_cmp_gt_u32 s30, 400000
  s_cbranch_scc0 Lpoll_9
Lpd_10:
  v_readfirstlane_b32 s31, v164
  s_nop 1
Lgn_8:
  v_mov_b32 v6, s31
  s_lshl_b32 s56, s3, 2
  v_mov_b32 v7, s56
  ds_write_b32 v7, v6 offset:16640
  s_cmp_ge_u32 s3, 2
  s_cbranch_scc1 Lpd__11
  v_mov_b32 v7, 0
Lpoll_12:
  ds_read_b128 v[20:23], v7 offset:16640
  s_waitcnt lgkmcnt(0)
  v_cmp_ne_u32 vcc, s31, v20
  v_cmp_ne_u32 s[58:59], s31, v21
  s_or_b64 vcc, vcc, s[58:59]
  v_cmp_ne_u32 s[58:59], s31, v22
  s_or_b64 vcc, vcc, s[58:59]
  v_cmp_ne_u32 s[58:59], s31, v23
  s_or_b64 vcc, vcc, s[58:59]
  s_cbranch_vccz Lpd_13
  s_add_u32 s30, s30, 1
  s_cmp_gt_u32 s30, 400000
  s_cbranch_scc0 Lpoll_12
Lpd_13:
  v_lshrrev_b32 v6, 3, v0
  v_lshlrev_b32 v6, 8, v6
  v_and_b32 v7, 7, v0
  v_lshl_add_u32 v6, v7, 4, v6
  s_lshl_b32 s56, s3, 7
  v_add_u32 v6, s56, v6
  ds_read_b128 v[20:23], v6 offset:0
  ds_read_b128 v[24:27], v6 offset:2048
  ds_read_b128 v[28:31], v6 offset:4096
  ds_read_b128 v[32:35], v6 offset:6144
  ds_read_b128 v[36:39], v6 offset:8192
  ds_read_b128 v[40:43], v6 offset:10240
  ds_read_b128 v[44:47], v6 offset:12288
  ds_read_b128 v[48:51], v6 offset:14336
  s_waitcnt lgkmcnt(0)
  v_add_f32 v20, v20, v24
  v_add_f32 v21, v21, v25
  v_add_f32 v22, v22, v26
  v_add_f32 v23, v23, v27
  v_add_f32 v28, v28, v32
  v_add_f32 v29, v29, v33
  v_add_f32 v30, v30, v34
  v_add_f32 v31, v31, v35
  v_add_f32 v36, v36, v40
  v_add_f32 v37, v37, v41
  v_add_f32 v38, v38, v42
  v_add_f32 v39, v39, v43
  v_add_f32 v44, v44, v48
  v_add_f32 v45, v45, v49
  v_add_f32 v46, v46, v50
  v_add_f32 v47, v47, v51
  v_add_f32 v20, v20, v28
  v_add_f32 v21, v21, v29
  v_add_f32 v22, v22, v30
  v_add_f32 v23, v23, v31
  v_add_f32 v36, v36, v44
  v_add_f32 v37, v37, v45
  v_add_f32 v38, v38, v46
  v_add_f32 v39, v39, v47
  v_add_f32 v8, v20, v36
  v_add_f32 v9, v21, v37
  v_add_f32 v10, v22, v38
  v_add_f32 v11, v23, v39
  v_cvt_pk_bf16_f32 v12, v8, v9
  v_cvt_pk_bf16_f32 v14, v10, v11
  v_mov_b32 v13, s31
  v_mov_b32 v15, s31
  s_lshl_b32 s56, s69, 11
  buffer_store_dwordx4 v[12:15], v6, s[36:39], s56 offen sc1
Lpd__11:
  s_branch L_QWAIT
L_P1C_A:
  s_sub_u32 s69, s2, 231
  s_branch L_P1C
L_P1C_B:
  s_sub_u32 s69, s2, 79
L_P1C:
  s_mov_b32 s48, s24
  s_mov_b32 s49, s25
  s_mov_b32 s50, 10240
  s_mov_b32 s51, 0x20000
  s_lshl_b32 s56, s69, 6
  s_add_u32 s44, s26, s56
  s_addc_u32 s45, s27, 0
  s_sub_u32 s46, 4915200, s56
  s_mov_b32 s47, 0x20000
  v_lshrrev_b32 v7, 3, v2
  v_lshlrev_b32 v7, 6, v7
  v_lshl_add_u32 v7, v1, 4, v7
  s_movk_i32 s57, 1280
  v_mul_lo_u32 v6, v3, s57
  v_add_u32 v6, v6, v7
  s_lshl_b32 s56, s3, 7
  buffer_load_dwordx4 v[8:11], v6, s[48:51], s56 offen offset:0
  buffer_load_dwordx4 v[12:15], v6, s[48:51], s56 offen offset:512
  buffer_load_dwordx4 v[16:19], v6, s[48:51], s56 offen offset:1024
  s_mov_b32 s57, 61440
  v_mul_lo_u32 v5, v1, s57
  v_lshl_add_u32 v5, v2, 2, v5
  s_add_u32 s56, s3, 0
  s_mul_i32 s56, s56, 491520
  buffer_load_dword v52, v5, s[44:47], s56 offen nt
  s_add_u32 s56, s56, 7680
  buffer_load_dword v56, v5, s[44:47], s56 offen nt
  s_add_u32 s56, s56, 7680
  buffer_load_dword v53, v5, s[44:47], s56 offen nt
  s_add_u32 s56, s56, 7680
  buffer_load_dword v57, v5, s[44:47], s56 offen nt
  s_add_u32 s56, s56, 7680
  buffer_load_dword v54, v5, s[44:47], s56 offen nt
  s_add_u32 s56, s56, 7680
  buffer_load_dword v58, v5, s[44:47], s56 offen nt
  s_add_u32 s56, s56, 7680
  buffer_load_dword v55, v5, s[44:47], s56 offen nt
  s_add_u32 s56, s56, 7680
  buffer_load_dword v59, v5, s[44:47], s56 offen nt
  s_add_u32 s56, s56, 192000
  buffer_load_dword v60, v5, s[44:47], s56 offen nt
  s_add_u32 s56, s56, 7680
  buffer_load_dword v64, v5, s[44:47], s56 offen nt
  s_add_u32 s56, s56, 7680
  buffer_load_dword v61, v5, s[44:47], s56 offen nt
  s_add_u32 s56, s56, 7680
  buffer_load_dword v65, v5, s[44:47], s56 offen nt
  s_add_u32 s56, s56, 7680
  buffer_load_dword v62, v5, s[44:47], s56 offen nt
  s_add_u32 s56, s56, 7680
  buffer_load_dword v66, v5, s[44:47], s56 offen nt
  s_add_u32 s56, s56, 7680
  buffer_load_dword v63, v5, s[44:47], s56 offen nt
  s_add_u32 s56, s56, 7680
  buffer_load_dword v67, v5, s[44:47], s56 offen nt
  s_add_u32 s56, s3, 4
  s_mul_i32 s56, s56, 491520
  buffer_load_dword v68, v5, s[44:47], s56 offen nt
  s_add_u32 s56, s56, 7680
  buffer_load_dword v72, v5, s[44:47], s56 offen nt
  s_add_u32 s56, s56, 7680
  buffer_load_dword v69, v5, s[44:47], s56 offen nt
  s_add_u32 s56, s56, 7680
  buffer_load_dword v73, v5, s[44:47], s56 offen nt
  s_add_u32 s56, s56, 7680
  buffer_load_dword v70, v5, s[44:47], s56 offen nt
  s_add_u32 s56, s56, 7680
  buffer_load_dword v74, v5, s[44:47], s56 offen nt
  s_add_u32 s56, s56, 7680
  buffer_load_dword v71, v5, s[44:47], s56 offen nt
  s_add_u32 s56, s56, 7680
  buffer_load_dword v75, v5, s[44:47], s56 offen nt
  s_add_u32 s56, s56, 192000
  buffer_load_dword v76, v5, s[44:47], s56 offen nt
  s_add_u32 s56, s56, 7680
  buffer_load_dword v80, v5, s[44:47], s56 offen nt
  s_add_u32 s56, s56, 7680
  buffer_load_dword v77, v5, s[44:47], s56 offen nt
  s_add_u32 s56, s56, 7680
  buffer_load_dword v81, v5, s[44:47], s56 offen nt
  s_add_u32 s56, s56, 7680
  buffer_load_dword v78, v5, s[44:47], s56 offen nt
  s_add_u32 s56, s56, 7680
  buffer_load_dword v82, v5, s[44:47], s56 offen nt
  s_add_u32 s56, s56, 7680
  buffer_load_dword v79, v5, s[44:47], s56 offen nt
  s_add_u32 s56, s56, 7680
  buffer_load_dword v83, v5, s[44:47], s56 offen nt
  s_cmp_ge_u32 s3, 2
  s_cbranch_scc1 Lskw_14
  s_add_u32 s56, s3, 8
  s_mul_i32 s56, s56, 491520
  buffer_load_dword v84, v5, s[44:47], s56 offen nt
  s_add_u32 s56, s56, 7680
  buffer_load_dword v88, v5, s[44:47], s56 offen nt
  s_add_u32 s56, s56, 7680
  buffer_load_dword v85, v5, s[44:47], s56 offen nt
  s_add_u32 s56, s56, 7680
  buffer_load_dword v89, v5, s[44:47], s56 offen nt
  s_add_u32 s56, s56, 7680
  buffer_load_dword v86, v5, s[44:47], s56 offen nt
  s_add_u32 s56, s56, 7680
  buffer_load_dword v90, v5, s[44:47], s56 offen nt
  s_add_u32 s56, s56, 7680
  buffer_load_dword v87, v5, s[44:47], s56 offen nt
  s_add_u32 s56, s56, 7680
  buffer_load_dword v91, v5, s[44:47], s56 offen nt
  s_add_u32 s56, s56, 192000
  buffer_load_dword v92, v5, s[44:47], s56 offen nt
  s_add_u32 s56, s56, 7680
  buffer_load_dword v96, v5, s[44:47], s56 offen nt
  s_add_u32 s56, s56, 7680
  buffer_load_dword v93, v5, s[44:47], s56 offen nt
  s_add_u32 s56, s56, 7680
  buffer_load_dword v97, v5, s[44:47], s56 offen nt
  s_add_u32 s56, s56, 7680
  buffer_load_dword v94, v5, s[44:47], s56 offen nt
  s_add_u32 s56, s56, 7680
  buffer_load_dword v98, v5, s[44:47], s56 offen nt
  s_add_u32 s56, s56, 7680
  buffer_load_dword v95, v5, s[44:47], s56 offen nt
  s_add_u32 s56, s56, 7680
  buffer_load_dword v99, v5, s[44:47], s56 offen nt
Lskw_14:
  v_mov_b32 v7, 0
  buffer_load_dword v4, v7, s[40:43], 0 offen sc1
  s_cmp_ge_u32 s3, 2
  s_cbranch_scc1 Lw_15
  s_waitcnt vmcnt(49)
  s_branch Lw_16
Lw_15:
  s_waitcnt vmcnt(33)
Lw_16:
  v_lshlrev_b32 v164, 16, v8
  v_and_b32 v165, 0xffff0000, v8
  v_mul_f32 v166, 0xbfb8aa3b, v164
  v_mul_f32 v167, 0xbfb8aa3b, v165
  v_exp_f32 v166, v166
  v_exp_f32 v167, v167
  s_nop 0
  v_add_f32 v166, 1.0, v166
  v_add_f32 v167, 1.0, v167
  v_rcp_f32 v166, v166
  v_rcp_f32 v167, v167
  s_nop 0
  v_mul_f32 v164, v164, v166
  v_mul_f32 v165, v165, v167
  v_cvt_pk_bf16_f32 v8, v164, v165
  v_lshlrev_b32 v164, 16, v9
  v_and_b32 v165, 0xffff0000, v9
  v_mul_f32 v166, 0xbfb8aa3b, v164
  v_mul_f32 v167, 0xbfb8aa3b, v165
  v_exp_f32 v166, v166
  v_exp_f32 v167, v167
  s_nop 0
  v_add_f32 v166, 1.0, v166
  v_add_f32 v167, 1.0, v167
  v_rcp_f32 v166, v166
  v_rcp_f32 v167, v167
  s_nop 0
  v_mul_f32 v164, v164, v166
  v_mul_f32 v165, v165, v167
  v_cvt_pk_bf16_f32 v9, v164, v165
  v_lshlrev_b32 v164, 16, v10
  v_and_b32 v165, 0xffff0000, v10
  v_mul_f32 v166, 0xbfb8aa3b, v164
  v_mul_f32 v167, 0xbfb8aa3b, v165
  v_exp_f32 v166, v166
  v_exp_f32 v167, v167
  s_nop 0
  v_add_f32 v166, 1.0, v166
  v_add_f32 v167, 1.0, v167
  v_rcp_f32 v166, v166
  v_rcp_f32 v167, v167
  s_nop 0
  v_mul_f32 v164, v164, v166
  v_mul_f32 v165, v165, v167
  v_cvt_pk_bf16_f32 v10, v164, v165
  v_lshlrev_b32 v164, 16, v11
  v_and_b32 v165, 0xffff0000, v11
  v_mul_f32 v166, 0xbfb8aa3b, v164
  v_mul_f32 v167, 0xbfb8aa3b, v165
  v_exp_f32 v166, v166
  v_exp_f32 v167, v167
  s_nop 0
  v_add_f32 v166, 1.0, v166
  v_add_f32 v167, 1.0, v167
  v_rcp_f32 v166, v166
  v_rcp_f32 v167, v167
  s_nop 0
  v_mul_f32 v164, v164, v166
  v_mul_f32 v165, v165, v167
  v_cvt_pk_bf16_f32 v11, v164, v165
  v_lshlrev_b32 v164, 16, v12
  v_and_b32 v165, 0xffff0000, v12
  v_mul_f32 v166, 0xbfb8aa3b, v164
  v_mul_f32 v167, 0xbfb8aa3b, v165
  v_exp_f32 v166, v166
  v_exp_f32 v167, v167
  s_nop 0
  v_add_f32 v166, 1.0, v166
  v_add_f32 v167, 1.0, v167
  v_rcp_f32 v166, v166
  v_rcp_f32 v167, v167
  s_nop 0
  v_mul_f32 v164, v164, v166
  v_mul_f32 v165, v165, v167
  v_cvt_pk_bf16_f32 v12, v164, v165
  v_lshlrev_b32 v164, 16, v13
  v_and_b32 v165, 0xffff0000, v13
  v_mul_f32 v166, 0xbfb8aa3b, v164
  v_mul_f32 v167, 0xbfb8aa3b, v165
  v_exp_f32 v166, v166
  v_exp_f32 v167, v167
  s_nop 0
  v_add_f32 v166, 1.0, v166
  v_add_f32 v167, 1.0, v167
  v_rcp_f32 v166, v166
  v_rcp_f32 v167, v167
  s_nop 0
  v_mul_f32 v164, v164, v166
  v_mul_f32 v165, v165, v167
  v_cvt_pk_bf16_f32 v13, v164, v165
  v_lshlrev_b32 v164, 16, v14
  v_and_b32 v165, 0xffff0000, v14
  v_mul_f32 v166, 0xbfb8aa3b, v164
  v_mul_f32 v167, 0xbfb8aa3b, v165
  v_exp_f32 v166, v166
  v_exp_f32 v167, v167
  s_nop 0
  v_add_f32 v166, 1.0, v166
  v_add_f32 v167, 1.0, v167
  v_rcp_f32 v166, v166
  v_rcp_f32 v167, v167
  s_nop 0
  v_mul_f32 v164, v164, v166
  v_mul_f32 v165, v165, v167
  v_cvt_pk_bf16_f32 v14, v164, v165
  v_lshlrev_b32 v164, 16, v15
  v_and_b32 v165, 0xffff0000, v15
  v_mul_f32 v166, 0xbfb8aa3b, v164
  v_mul_f32 v167, 0xbfb8aa3b, v165
  v_exp_f32 v166, v166
  v_exp_f32 v167, v167
  s_nop 0
  v_add_f32 v166, 1.0, v166
  v_add_f32 v167, 1.0, v167
  v_rcp_f32 v166, v166
  v_rcp_f32 v167, v167
  s_nop 0
  v_mul_f32 v164, v164, v166
  v_mul_f32 v165, v165, v167
  v_cvt_pk_bf16_f32 v15, v164, v165
  s_cmp_ge_u32 s3, 2
  s_cbranch_scc1 Lsk3_17
  v_lshlrev_b32 v164, 16, v16
  v_and_b32 v165, 0xffff0000, v16
  v_mul_f32 v166, 0xbfb8aa3b, v164
  v_mul_f32 v167, 0xbfb8aa3b, v165
  v_exp_f32 v166, v166
  v_exp_f32 v167, v167
  s_nop 0
  v_add_f32 v166, 1.0, v166
  v_add_f32 v167, 1.0, v167
  v_rcp_f32 v166, v166
  v_rcp_f32 v167, v167
  s_nop 0
  v_mul_f32 v164, v164, v166
  v_mul_f32 v165, v165, v167
  v_cvt_pk_bf16_f32 v16, v164, v165
  v_lshlrev_b32 v164, 16, v17
  v_and_b32 v165, 0xffff0000, v17
  v_mul_f32 v166, 0xbfb8aa3b, v164
  v_mul_f32 v167, 0xbfb8aa3b, v165
  v_exp_f32 v166, v166
  v_exp_f32 v167, v167
  s_nop 0
  v_add_f32 v166, 1.0, v166
  v_add_f32 v167, 1.0, v167
  v_rcp_f32 v166, v166
  v_rcp_f32 v167, v167
  s_nop 0
  v_mul_f32 v164, v164, v166
  v_mul_f32 v165, v165, v167
  v_cvt_pk_bf16_f32 v17, v164, v165
  v_lshlrev_b32 v164, 16, v18
  v_and_b32 v165, 0xffff0000, v18
  v_mul_f32 v166, 0xbfb8aa3b, v164
  v_mul_f32 v167, 0xbfb8aa3b, v165
  v_exp_f32 v166, v166
  v_exp_f32 v167, v167
  s_nop 0
  v_add_f32 v166, 1.0, v166
  v_add_f32 v167, 1.0, v167
  v_rcp_f32 v166, v166
  v_rcp_f32 v167, v167
  s_nop 0
  v_mul_f32 v164, v164, v166
  v_mul_f32 v165, v165, v167
  v_cvt_pk_bf16_f32 v18, v164, v165
  v_lshlrev_b32 v164, 16, v19
  v_and_b32 v165, 0xffff0000, v19
  v_mul_f32 v166, 0xbfb8aa3b, v164
  v_mul_f32 v167, 0xbfb8aa3b, v165
  v_exp_f32 v166, v166
  v_exp_f32 v167, v167
  s_nop 0
  v_add_f32 v166, 1.0, v166
  v_add_f32 v167, 1.0, v167
  v_rcp_f32 v166, v166
  v_rcp_f32 v167, v167
  s_nop 0
  v_mul_f32 v164, v164, v166
  v_mul_f32 v165, v165, v167
  v_cvt_pk_bf16_f32 v19, v164, v165
Lsk3_17:
  s_waitcnt vmcnt(0)
  v_perm_b32 v148, v56, v52, s60
  v_perm_b32 v152, v56, v52, s61
  v_perm_b32 v149, v57, v53, s60
  v_perm_b32 v153, v57, v53, s61
  v_perm_b32 v150, v58, v54, s60
  v_perm_b32 v154, v58, v54, s61
  v_perm_b32 v151, v59, v55, s60
  v_perm_b32 v155, v59, v55, s61
  s_nop 1
  v_mfma_f32_16x16x32_bf16 v[20:23], v[8:11], v[148:151], 0
  v_mfma_f32_16x16x32_bf16 v[24:27], v[8:11], v[152:155], 0
  v_perm_b32 v148, v64, v60, s60
  v_perm_b32 v152, v64, v60, s61
  v_perm_b32 v149, v65, v61, s60
  v_perm_b32 v153, v65, v61, s61
  v_perm_b32 v150, v66, v62, s60
  v_perm_b32 v154, v66, v62, s61
  v_perm_b32 v151, v67, v63, s60
  v_perm_b32 v155, v67, v63, s61
  s_nop 1
  v_mfma_f32_16x16x32_bf16 v[28:31], v[8:11], v[148:151], 0
  v_mfma_f32_16x16x32_bf16 v[32:35], v[8:11], v[152:155], 0
  v_perm_b32 v148, v72, v68, s60
  v_perm_b32 v152, v72, v68, s61
  v_perm_b32 v149, v73, v69, s60
  v_perm_b32 v153, v73, v69, s61
  v_perm_b32 v150, v74, v70, s60
  v_perm_b32 v154, v74, v70, s61
  v_perm_b32 v151, v75, v71, s60
  v_perm_b32 v155, v75, v71, s61
  s_nop 1
  v_mfma_f32_16x16x32_bf16 v[20:23], v[12:15], v[148:151], v[20:23]
  v_mfma_f32_16x16x32_bf16 v[24:27], v[12:15], v[152:155], v[24:27]
  v_perm_b32 v148, v80, v76, s60
  v_perm_b32 v152, v80, v76, s61
  v_perm_b32 v149, v81, v77, s60
  v_perm_b32 v153, v81, v77, s61
  v_perm_b32 v150, v82, v78, s60
  v_perm_b32 v154, v82, v78, s61
  v_perm_b32 v151, v83, v79, s60
  v_perm_b32 v155, v83, v79, s61
  s_nop 1
  v_mfma_f32_16x16x32_bf16 v[28:31], v[12:15], v[148:151], v[28:31]
  v_mfma_f32_16x16x32_bf16 v[32:35], v[12:15], v[152:155], v[32:35]
  s_cmp_ge_u32 s3, 2
  s_cbranch_scc1 Lsk3_18
  v_perm_b32 v148, v88, v84, s60
  v_perm_b32 v152, v88, v84, s61
  v_perm_b32 v149, v89, v85, s60
  v_perm_b32 v153, v89, v85, s61
  v_perm_b32 v150, v90, v86, s60
  v_perm_b32 v154, v90, v86, s61
  v_perm_b32 v151, v91, v87, s60
  v_perm_b32 v155, v91, v87, s61
  s_nop 1
  v_mfma_f32_16x16x32_bf16 v[20:23], v[16:19], v[148:151], v[20:23]
  v_mfma_f32_16x16x32_bf16 v[24:27], v[16:19], v[152:155], v[24:27]
  v_perm_b32 v148, v96, v92, s60
  v_perm_b32 v152, v96, v92, s61
  v_perm_b32 v149, v97, v93, s60
  v_perm_b32 v153, v97, v93, s61
  v_perm_b32 v150, v98, v94, s60
  v_perm_b32 v154, v98, v94, s61
  v_perm_b32 v151, v99, v95, s60
  v_perm_b32 v155, v99, v95, s61
  s_nop 1
  v_mfma_f32_16x16x32_bf16 v[28:31], v[16:19], v[148:151], v[28:31]
  v_mfma_f32_16x16x32_bf16 v[32:35], v[16:19], v[152:155], v[32:35]
Lsk3_18:
  v_readfirstlane_b32 s31, v4
  v_lshrrev_b32 v6, 1, v1
  v_lshlrev_b32 v6, 10, v6
  v_and_b32 v7, 1, v1
  v_lshl_add_u32 v6, v7, 9, v6
  v_lshl_add_u32 v6, v2, 3, v6
  s_lshl_b32 s56, s3, 11
  v_add_u32 v6, s56, v6
  s_mov_b32 s58, 0
  s_mov_b32 s59, -1
  s_nop 3
  v_cndmask_b32 v52, v20, v28, s[58:59]
  v_cndmask_b32 v53, v24, v32, s[58:59]
  v_cndmask_b32 v54, v21, v29, s[58:59]
  v_cndmask_b32 v55, v25, v33, s[58:59]
  v_cndmask_b32 v56, v22, v30, s[58:59]
  v_cndmask_b32 v57, v26, v34, s[58:59]
  v_cndmask_b32 v58, v23, v31, s[58:59]
  v_cndmask_b32 v59, v27, v35, s[58:59]
  ds_write_b64 v6, v[52:53] offset:0
  ds_write_b64 v6, v[54:55] offset:128
  ds_write_b64 v6, v[56:57] offset:256
  ds_write_b64 v6, v[58:59] offset:384
  s_waitcnt lgkmcnt(0)
  s_cmp_lg_u32 s31, 0
  s_cbranch_scc1 Lgn_19
  v_mov_b32 v165, 0
Lpoll_20:
  buffer_load_dword v164, v165, s[40:43], 0 offen sc1
  s_waitcnt vmcnt(0)
  v_cmp_eq_u32 vcc, 0, v164
  s_cbranch_vccz Lpd_21
  s_sleep 1
  s_add_u32 s30, s30, 1
  s_cmp_gt_u32 s30, 400000
  s_cbranch_scc0 Lpoll_20
Lpd_21:
  v_readfirstlane_b32 s31, v164
  s_nop 1
Lgn_19:
  v_mov_b32 v6, s31
  s_lshl_b32 s56, s3, 2
  v_mov_b32 v7, s56
  ds_write_b32 v7, v6 offset:16640
  s_cmp_lg_u32 s3, 0
  s_cbranch_scc1 Lp1c_22
  v_mov_b32 v7, 0
Lpoll_23:
  ds_read_b128 v[20:23], v7 offset:16640
  s_waitcnt lgkmcnt(0)
  v_cmp_ne_u32 vcc, s31, v20
  v_cmp_ne_u32 s[58:59], s31, v21
  s_or_b64 vcc, vcc, s[58:59]
  v_cmp_ne_u32 s[58:59], s31, v22
  s_or_b64 vcc, vcc, s[58:59]
  v_cmp_ne_u32 s[58:59], s31, v23
  s_or_b64 vcc, vcc, s[58:59]
  s_cbranch_vccz Lpd_24
  s_add_u32 s30, s30, 1
  s_cmp_gt_u32 s30, 400000
  s_cbranch_scc0 Lpoll_23
Lpd_24:
  v_lshlrev_b32 v6, 4, v0
  ds_read_b128 v[20:23], v6 offset:0
  ds_read_b128 v[24:27], v6 offset:1024
  ds_read_b128 v[28:31], v6 offset:2048
  ds_read_b128 v[32:35], v6 offset:3072
  ds_read_b128 v[36:39], v6 offset:4096
  ds_read_b128 v[40:43], v6 offset:5120
  ds_read_b128 v[44:47], v6 offset:6144
  ds_read_b128 v[48:51], v6 offset:7168
  s_waitcnt lgkmcnt(0)
  v_add_f32 v20, v20, v24
  v_add_f32 v28, v28, v32
  v_add_f32 v36, v36, v40
  v_add_f32 v44, v44, v48
  v_add_f32 v20, v20, v28
  v_add_f32 v36, v36, v44
  v_add_f32 v8, v20, v36
  v_add_f32 v21, v21, v25
  v_add_f32 v29, v29, v33
  v_add_f32 v37, v37, v41
  v_add_f32 v45, v45, v49
  v_add_f32 v21, v21, v29
  v_add_f32 v37, v37, v45
  v_add_f32 v9, v21, v37
  v_add_f32 v22, v22, v26
  v_add_f32 v30, v30, v34
  v_add_f32 v38, v38, v42
  v_add_f32 v46, v46, v50
  v_add_f32 v22, v22, v30
  v_add_f32 v38, v38, v46
  v_add_f32 v10, v22, v38
  v_add_f32 v23, v23, v27
  v_add_f32 v31, v31, v35
  v_add_f32 v39, v39, v43
  v_add_f32 v47, v47, v51
  v_add_f32 v23, v23, v31
  v_add_f32 v39, v39, v47
  v_add_f32 v11, v23, v39
  v_lshrrev_b32 v6, 3, v0
  v_lshlrev_b32 v6, 8, v6
  v_and_b32 v7, 7, v0
  v_lshl_add_u32 v6, v7, 4, v6
  v_cvt_pk_bf16_f32 v12, v8, v9
  v_cvt_pk_bf16_f32 v14, v10, v11
  v_mov_b32 v13, s31
  v_mov_b32 v15, s31
  s_lshr_b32 s56, s69, 1
  s_lshl_b32 s56, s56, 11
  s_and_b32 s57, s69, 1
  s_lshl_b32 s57, s57, 7
  s_add_u32 s56, s56, s57
  buffer_store_dwordx4 v[12:15], v6, s[36:39], s56 offen sc1
Lp1c_22:
  s_branch L_QWAIT
L_PNONE:
  v_mov_b32 v165, 0
Lpoll_25:
  buffer_load_dword v164, v165, s[40:43], 0 offen sc1
  s_waitcnt vmcnt(0)
  v_cmp_eq_u32 vcc, 0, v164
  s_cbranch_vccz Lpd_26
  s_sleep 1
  s_add_u32 s30, s30, 1
  s_cmp_gt_u32 s30, 400000
  s_cbranch_scc0 Lpoll_25
Lpd_26:
  v_readfirstlane_b32 s31, v164
  s_nop 1
  s_branch L_QWAIT
L_P2:
  s_mov_b32 s48, s8
  s_mov_b32 s49, s9
  s_mov_b32 s50, 10240
  s_mov_b32 s51, 0x20000
  s_sub_u32 s69, s2, 40
  s_lshl_b32 s56, s69, 7
  s_add_u32 s44, s14, s56
  s_addc_u32 s45, s15, 0
  s_sub_u32 s46, 5242880, s56
  s_mov_b32 s47, 0x20000
  s_movk_i32 s57, 1280
  v_mul_lo_u32 v6, v3, s57
  v_lshrrev_b32 v7, 3, v0
  v_mul_lo_u32 v7, v7, s57
  v_and_b32 v5, 7, v0
  v_lshl_add_u32 v7, v5, 4, v7
  buffer_load_dwordx4 v[20:23], v7, s[48:51], 0 offen offset:0
  buffer_load_dwordx4 v[24:27], v7, s[48:51], 0 offen offset:128
  buffer_load_dwordx4 v[28:31], v7, s[48:51], 0 offen offset:256
  buffer_load_dwordx4 v[32:35], v7, s[48:51], 0 offen offset:384
  buffer_load_dwordx4 v[36:39], v7, s[48:51], 0 offen offset:512
  buffer_load_dwordx4 v[40:43], v7, s[48:51], 0 offen offset:640
  buffer_load_dwordx4 v[44:47], v7, s[48:51], 0 offen offset:768
  buffer_load_dwordx4 v[48:51], v7, s[48:51], 0 offen offset:896
  buffer_load_dwordx4 v[52:55], v7, s[48:51], 0 offen offset:1024
  buffer_load_dwordx4 v[56:59], v7, s[48:51], 0 offen offset:1152
  v_lshrrev_b32 v5, 3, v2
  v_lshlrev_b32 v5, 6, v5
  v_lshl_add_u32 v5, v1, 4, v5
  v_add_u32 v6, v6, v5
  s_lshl_b32 s56, s3, 7
  buffer_load_dwordx4 v[8:11], v6, s[48:51], s56 offen offset:0
  buffer_load_dwordx4 v[12:15], v6, s[48:51], s56 offen offset:512
  buffer_load_dwordx4 v[16:19], v6, s[48:51], s56 offen offset:1024
  s_mov_b32 s57, 65536
  v_mul_lo_u32 v5, v1, s57
  v_lshl_add_u32 v5, v2, 3, v5
  s_add_u32 s56, s3, 0
  s_mul_i32 s56, s56, 524288
  buffer_load_dwordx2 v[68:69], v5, s[44:47], s56 offen nt
  s_add_u32 s56, s56, 8192
  buffer_load_dwordx2 v[70:71], v5, s[44:47], s56 offen nt
  s_add_u32 s56, s56, 8192
  buffer_load_dwordx2 v[72:73], v5, s[44:47], s56 offen nt
  s_add_u32 s56, s56, 8192
  buffer_load_dwordx2 v[74:75], v5, s[44:47], s56 offen nt
  s_add_u32 s56, s56, 8192
  buffer_load_dwordx2 v[76:77], v5, s[44:47], s56 offen nt
  s_add_u32 s56, s56, 8192
  buffer_load_dwordx2 v[78:79], v5, s[44:47], s56 offen nt
  s_add_u32 s56, s56, 8192
  buffer_load_dwordx2 v[80:81], v5, s[44:47], s56 offen nt
  s_add_u32 s56, s56, 8192
  buffer_load_dwordx2 v[82:83], v5, s[44:47], s56 offen nt
  s_add_u32 s56, s56, 204800
  buffer_load_dwordx2 v[84:85], v5, s[44:47], s56 offen nt
  s_add_u32 s56, s56, 8192
  buffer_load_dwordx2 v[86:87], v5, s[44:47], s56 offen nt
  s_add_u32 s56, s56, 8192
  buffer_load_dwordx2 v[88:89], v5, s[44:47], s56 offen nt
  s_add_u32 s56, s56, 8192
  buffer_load_dwordx2 v[90:91], v5, s[44:47], s56 offen nt
  s_add_u32 s56, s56, 8192
  buffer_load_dwordx2 v[92:93], v5, s[44:47], s56 offen nt
  s_add_u32 s56, s56, 8192
  buffer_load_dwordx2 v[94:95], v5, s[44:47], s56 offen nt
  s_add_u32 s56, s56, 8192
  buffer_load_dwordx2 v[96:97], v5, s[44:47], s56 offen nt
  s_add_u32 s56, s56, 8192
  buffer_load_dwordx2 v[98:99], v5, s[44:47], s56 offen nt
  s_add_u32 s56, s3, 4
  s_mul_i32 s56, s56, 524288
  buffer_load_dwordx2 v[100:101], v5, s[44:47], s56 offen nt
  s_add_u32 s56, s56, 8192
  buffer_load_dwordx2 v[102:103], v5, s[44:47], s56 offen nt
  s_add_u32 s56, s56, 8192
  buffer_load_dwordx2 v[104:105], v5, s[44:47], s56 offen nt
  s_add_u32 s56, s56, 8192
  buffer_load_dwordx2 v[106:107], v5, s[44:47], s56 offen nt
  s_add_u32 s56, s56, 8192
  buffer_load_dwordx2 v[108:109], v5, s[44:47], s56 offen nt
  s_add_u32 s56, s56, 8192
  buffer_load_dwordx2 v[110:111], v5, s[44:47], s56 offen nt
  s_add_u32 s56, s56, 8192
  buffer_load_dwordx2 v[112:113], v5, s[44:47], s56 offen nt
  s_add_u32 s56, s56, 8192
  buffer_load_dwordx2 v[114:115], v5, s[44:47], s56 offen nt
  s_add_u32 s56, s56, 204800
  buffer_load_dwordx2 v[116:117], v5, s[44:47], s56 offen nt
  s_add_u32 s56, s56, 8192
  buffer_load_dwordx2 v[118:119], v5, s[44:47], s56 offen nt
  s_add_u32 s56, s56, 8192
  buffer_load_dwordx2 v[120:121], v5, s[44:47], s56 offen nt
  s_add_u32 s56, s56, 8192
  buffer_load_dwordx2 v[122:123], v5, s[44:47], s56 offen nt
  s_add_u32 s56, s56, 8192
  buffer_load_dwordx2 v[124:125], v5, s[44:47], s56 offen nt
  s_add_u32 s56, s56, 8192
  buffer_load_dwordx2 v[126:127], v5, s[44:47], s56 offen nt
  s_add_u32 s56, s56, 8192
  buffer_load_dwordx2 v[128:129], v5, s[44:47], s56 offen nt
  s_add_u32 s56, s56, 8192
  buffer_load_dwordx2 v[130:131], v5, s[44:47], s56 offen nt
  s_cmp_ge_u32 s3, 2
  s_cbranch_scc1 Lskw_27
  s_add_u32 s56, s3, 8
  s_mul_i32 s56, s56, 524288
  buffer_load_dwordx2 v[132:133], v5, s[44:47], s56 offen nt
  s_add_u32 s56, s56, 8192
  buffer_load_dwordx2 v[134:135], v5, s[44:47], s56 offen nt
  s_add_u32 s56, s56, 8192
  buffer_load_dwordx2 v[136:137], v5, s[44:47], s56 offen nt
  s_add_u32 s56, s56, 8192
  buffer_load_dwordx2 v[138:139], v5, s[44:47], s56 offen nt
  s_add_u32 s56, s56, 8192
  buffer_load_dwordx2 v[140:141], v5, s[44:47], s56 offen nt
  s_add_u32 s56, s56, 8192
  buffer_load_dwordx2 v[142:143], v5, s[44:47], s56 offen nt
  s_add_u32 s56, s56, 8192
  buffer_load_dwordx2 v[144:145], v5, s[44:47], s56 offen nt
  s_add_u32 s56, s56, 8192
  buffer_load_dwordx2 v[146:147], v5, s[44:47], s56 offen nt
  s_add_u32 s56, s56, 204800
  buffer_load_dwordx2 v[148:149], v5, s[44:47], s56 offen nt
  s_add_u32 s56, s56, 8192
  buffer_load_dwordx2 v[150:151], v5, s[44:47], s56 offen nt
  s_add_u32 s56, s56, 8192
  buffer_load_dwordx2 v[152:153], v5, s[44:47], s56 offen nt
  s_add_u32 s56, s56, 8192
  buffer_load_dwordx2 v[154:155], v5, s[44:47], s56 offen nt
  s_add_u32 s56, s56, 8192
  buffer_load_dwordx2 v[156:157], v5, s[44:47], s56 offen nt
  s_add_u32 s56, s56, 8192
  buffer_load_dwordx2 v[158:159], v5, s[44:47], s56 offen nt
  s_add_u32 s56, s56, 8192
  buffer_load_dwordx2 v[160:161], v5, s[44:47], s56 offen nt
  s_add_u32 s56, s56, 8192
  buffer_load_dwordx2 v[162:163], v5, s[44:47], s56 offen nt
Lskw_27:
  s_cmp_ge_u32 s3, 2
  s_cbranch_scc1 Lw_28
  s_waitcnt vmcnt(48)
  s_branch Lw_29
Lw_28:
  s_waitcnt vmcnt(32)
Lw_29:
  v_mov_b32 v166, 0
  v_mov_b32 v167, 0
  v_lshlrev_b32 v164, 16, v20
  v_and_b32 v165, 0xffff0000, v20
  v_add_f32 v166, v166, v164
  v_fmac_f32 v167, v164, v164
  v_add_f32 v166, v166, v165
  v_fmac_f32 v167, v165, v165
  v_lshlrev_b32 v164, 16, v21
  v_and_b32 v165, 0xffff0000, v21
  v_add_f32 v166, v166, v164
  v_fmac_f32 v167, v164, v164
  v_add_f32 v166, v166, v165
  v_fmac_f32 v167, v165, v165
  v_lshlrev_b32 v164, 16, v22
  v_and_b32 v165, 0xffff0000, v22
  v_add_f32 v166, v166, v164
  v_fmac_f32 v167, v164, v164
  v_add_f32 v166, v166, v165
  v_fmac_f32 v167, v165, v165
  v_lshlrev_b32 v164, 16, v23
  v_and_b32 v165, 0xffff0000, v23
  v_add_f32 v166, v166, v164
  v_fmac_f32 v167, v164, v164
  v_add_f32 v166, v166, v165
  v_fmac_f32 v167, v165, v165
  v_lshlrev_b32 v164, 16, v24
  v_and_b32 v165, 0xffff0000, v24
  v_add_f32 v166, v166, v164
  v_fmac_f32 v167, v164, v164
  v_add_f32 v166, v166, v165
  v_fmac_f32 v167, v165, v165
  v_lshlrev_b32 v164, 16, v25
  v_and_b32 v165, 0xffff0000, v25
  v_add_f32 v166, v166, v164
  v_fmac_f32 v167, v164, v164
  v_add_f32 v166, v166, v165
  v_fmac_f32 v167, v165, v165
  v_lshlrev_b32 v164, 16, v26
  v_and_b32 v165, 0xffff0000, v26
  v_add_f32 v166, v166, v164
  v_fmac_f32 v167, v164, v164
  v_add_f32 v166, v166, v165
  v_fmac_f32 v167, v165, v165
  v_lshlrev_b32 v164, 16, v27
  v_and_b32 v165, 0xffff0000, v27
  v_add_f32 v166, v166, v164
  v_fmac_f32 v167, v164, v164
  v_add_f32 v166, v166, v165
  v_fmac_f32 v167, v165, v165
  v_lshlrev_b32 v164, 16, v28
  v_and_b32 v165, 0xffff0000, v28
  v_add_f32 v166, v166, v164
  v_fmac_f32 v167, v164, v164
  v_add_f32 v166, v166, v165
  v_fmac_f32 v167, v165, v165
  v_lshlrev_b32 v164, 16, v29
  v_and_b32 v165, 0xffff0000, v29
  v_add_f32 v166, v166, v164
  v_fmac_f32 v167, v164, v164
  v_add_f32 v166, v166, v165
  v_fmac_f32 v167, v165, v165
  v_lshlrev_b32 v164, 16, v30
  v_and_b32 v165, 0xffff0000, v30
  v_add_f32 v166, v166, v164
  v_fmac_f32 v167, v164, v164
  v_add_f32 v166, v166, v165
  v_fmac_f32 v167, v165, v165
  v_lshlrev_b32 v164, 16, v31
  v_and_b32 v165, 0xffff0000, v31
  v_add_f32 v166, v166, v164
  v_fmac_f32 v167, v164, v164
  v_add_f32 v166, v166, v165
  v_fmac_f32 v167, v165, v165
  v_lshlrev_b32 v164, 16, v32
  v_and_b32 v165, 0xffff0000, v32
  v_add_f32 v166, v166, v164
  v_fmac_f32 v167, v164, v164
  v_add_f32 v166, v166, v165
  v_fmac_f32 v167, v165, v165
  v_lshlrev_b32 v164, 16, v33
  v_and_b32 v165, 0xffff0000, v33
  v_add_f32 v166, v166, v164
  v_fmac_f32 v167, v164, v164
  v_add_f32 v166, v166, v165
  v_fmac_f32 v167, v165, v165
  v_lshlrev_b32 v164, 16, v34
  v_and_b32 v165, 0xffff0000, v34
  v_add_f32 v166, v166, v164
  v_fmac_f32 v167, v164, v164
  v_add_f32 v166, v166, v165
  v_fmac_f32 v167, v165, v165
  v_lshlrev_b32 v164, 16, v35
  v_and_b32 v165, 0xffff0000, v35
  v_add_f32 v166, v166, v164
  v_fmac_f32 v167, v164, v164
  v_add_f32 v166, v166, v165
  v_fmac_f32 v167, v165, v165
  v_lshlrev_b32 v164, 16, v36
  v_and_b32 v165, 0xffff0000, v36
  v_add_f32 v166, v166, v164
  v_fmac_f32 v167, v164, v164
  v_add_f32 v166, v166, v165
  v_fmac_f32 v167, v165, v165
  v_lshlrev_b32 v164, 16, v37
  v_and_b32 v165, 0xffff0000, v37
  v_add_f32 v166, v166, v164
  v_fmac_f32 v167, v164, v164
  v_add_f32 v166, v166, v165
  v_fmac_f32 v167, v165, v165
  v_lshlrev_b32 v164, 16, v38
  v_and_b32 v165, 0xffff0000, v38
  v_add_f32 v166, v166, v164
  v_fmac_f32 v167, v164, v164
  v_add_f32 v166, v166, v165
  v_fmac_f32 v167, v165, v165
  v_lshlrev_b32 v164, 16, v39
  v_and_b32 v165, 0xffff0000, v39
  v_add_f32 v166, v166, v164
  v_fmac_f32 v167, v164, v164
  v_add_f32 v166, v166, v165
  v_fmac_f32 v167, v165, v165
  v_lshlrev_b32 v164, 16, v40
  v_and_b32 v165, 0xffff0000, v40
  v_add_f32 v166, v166, v164
  v_fmac_f32 v167, v164, v164
  v_add_f32 v166, v166, v165
  v_fmac_f32 v167, v165, v165
  v_lshlrev_b32 v164, 16, v41
  v_and_b32 v165, 0xffff0000, v41
  v_add_f32 v166, v166, v164
  v_fmac_f32 v167, v164, v164
  v_add_f32 v166, v166, v165
  v_fmac_f32 v167, v165, v165
  v_lshlrev_b32 v164, 16, v42
  v_and_b32 v165, 0xffff0000, v42
  v_add_f32 v166, v166, v164
  v_fmac_f32 v167, v164, v164
  v_add_f32 v166, v166, v165
  v_fmac_f32 v167, v165, v165
  v_lshlrev_b32 v164, 16, v43
  v_and_b32 v165, 0xffff0000, v43
  v_add_f32 v166, v166, v164
  v_fmac_f32 v167, v164, v164
  v_add_f32 v166, v166, v165
  v_fmac_f32 v167, v165, v165
  v_lshlrev_b32 v164, 16, v44
  v_and_b32 v165, 0xffff0000, v44
  v_add_f32 v166, v166, v164
  v_fmac_f32 v167, v164, v164
  v_add_f32 v166, v166, v165
  v_fmac_f32 v167, v165, v165
  v_lshlrev_b32 v164, 16, v45
  v_and_b32 v165, 0xffff0000, v45
  v_add_f32 v166, v166, v164
  v_fmac_f32 v167, v164, v164
  v_add_f32 v166, v166, v165
  v_fmac_f32 v167, v165, v165
  v_lshlrev_b32 v164, 16, v46
  v_and_b32 v165, 0xffff0000, v46
  v_add_f32 v166, v166, v164
  v_fmac_f32 v167, v164, v164
  v_add_f32 v166, v166, v165
  v_fmac_f32 v167, v165, v165
  v_lshlrev_b32 v164, 16, v47
  v_and_b32 v165, 0xffff0000, v47
  v_add_f32 v166, v166, v164
  v_fmac_f32 v167, v164, v164
  v_add_f32 v166, v166, v165
  v_fmac_f32 v167, v165, v165
  v_lshlrev_b32 v164, 16, v48
  v_and_b32 v165, 0xffff0000, v48
  v_add_f32 v166, v166, v164
  v_fmac_f32 v167, v164, v164
  v_add_f32 v166, v166, v165
  v_fmac_f32 v167, v165, v165
  v_lshlrev_b32 v164, 16, v49
  v_and_b32 v165, 0xffff0000, v49
  v_add_f32 v166, v166, v164
  v_fmac_f32 v167, v164, v164
  v_add_f32 v166, v166, v165
  v_fmac_f32 v167, v165, v165
  v_lshlrev_b32 v164, 16, v50
  v_and_b32 v165, 0xffff0000, v50
  v_add_f32 v166, v166, v164
  v_fmac_f32 v167, v164, v164
  v_add_f32 v166, v166, v165
  v_fmac_f32 v167, v165, v165
  v_lshlrev_b32 v164, 16, v51
  v_and_b32 v165, 0xffff0000, v51
  v_add_f32 v166, v166, v164
  v_fmac_f32 v167, v164, v164
  v_add_f32 v166, v166, v165
  v_fmac_f32 v167, v165, v165
  v_lshlrev_b32 v164, 16, v52
  v_and_b32 v165, 0xffff0000, v52
  v_add_f32 v166, v166, v164
  v_fmac_f32 v167, v164, v164
  v_add_f32 v166, v166, v165
  v_fmac_f32 v167, v165, v165
  v_lshlrev_b32 v164, 16, v53
  v_and_b32 v165, 0xffff0000, v53
  v_add_f32 v166, v166, v164
  v_fmac_f32 v167, v164, v164
  v_add_f32 v166, v166, v165
  v_fmac_f32 v167, v165, v165
  v_lshlrev_b32 v164, 16, v54
  v_and_b32 v165, 0xffff0000, v54
  v_add_f32 v166, v166, v164
  v_fmac_f32 v167, v164, v164
  v_add_f32 v166, v166, v165
  v_fmac_f32 v167, v165, v165
  v_lshlrev_b32 v164, 16, v55
  v_and_b32 v165, 0xffff0000, v55
  v_add_f32 v166, v166, v164
  v_fmac_f32 v167, v164, v164
  v_add_f32 v166, v166, v165
  v_fmac_f32 v167, v165, v165
  v_lshlrev_b32 v164, 16, v56
  v_and_b32 v165, 0xffff0000, v56
  v_add_f32 v166, v166, v164
  v_fmac_f32 v167, v164, v164
  v_add_f32 v166, v166, v165
  v_fmac_f32 v167, v165, v165
  v_lshlrev_b32 v164, 16, v57
  v_and_b32 v165, 0xffff0000, v57
  v_add_f32 v166, v166, v164
  v_fmac_f32 v167, v164, v164
  v_add_f32 v166, v166, v165
  v_fmac_f32 v167, v165, v165
  v_lshlrev_b32 v164, 16, v58
  v_and_b32 v165, 0xffff0000, v58
  v_add_f32 v166, v166, v164
  v_fmac_f32 v167, v164, v164
  v_add_f32 v166, v166, v165
  v_fmac_f32 v167, v165, v165
  v_lshlrev_b32 v164, 16, v59
  v_and_b32 v165, 0xffff0000, v59
  v_add_f32 v166, v166, v164
  v_fmac_f32 v167, v164, v164
  v_add_f32 v166, v166, v165
  v_fmac_f32 v167, v165, v165
  s_nop 1
  v_add_f32_dpp v166, v166, v166 quad_perm:[1,0,3,2] row_mask:0xf bank_mask:0xf
  s_nop 1
  v_add_f32_dpp v166, v166, v166 quad_perm:[2,3,0,1] row_mask:0xf bank_mask:0xf
  s_nop 1
  v_add_f32_dpp v166, v166, v166 row_half_mirror row_mask:0xf bank_mask:0xf
  s_nop 1
  v_add_f32_dpp v167, v167, v167 quad_perm:[1,0,3,2] row_mask:0xf bank_mask:0xf
  s_nop 1
  v_add_f32_dpp v167, v167, v167 quad_perm:[2,3,0,1] row_mask:0xf bank_mask:0xf
  s_nop 1
  v_add_f32_dpp v167, v167, v167 row_half_mirror row_mask:0xf bank_mask:0xf
  v_lshlrev_b32 v164, 5, v3
  ds_bpermute_b32 v166, v164, v166
  ds_bpermute_b32 v167, v164, v167
  s_waitcnt lgkmcnt(0)
  v_mul_f32 v166, 0x3acccccd, v166
  v_mul_f32 v167, 0x3acccccd, v167
  v_fma_f32 v167, -v166, v166, v167
  v_max_f32 v167, 0, v167
  v_cvt_pk_bf16_f32 v164, v166, v167
  v_lshlrev_b32 v6, 16, v164
  v_and_b32 v167, 0xffff0000, v164
  v_add_f32 v167, 0x3727c5ac, v167
  v_cvt_pk_bf16_f32 v164, v167, v167
  v_lshlrev_b32 v167, 16, v164
  v_sqrt_f32 v167, v167
  s_nop 0
  v_cvt_pk_bf16_f32 v164, v167, v167
  v_lshlrev_b32 v167, 16, v164
  v_rcp_f32 v7, v167
  s_nop 0
  v_lshlrev_b32 v164, 16, v8
  v_and_b32 v165, 0xffff0000, v8
  v_sub_f32 v164, v164, v6
  v_sub_f32 v165, v165, v6
  v_cvt_pk_bf16_f32 v166, v164, v165
  v_lshlrev_b32 v164, 16, v166
  v_and_b32 v165, 0xffff0000, v166
  v_mul_f32 v164, v164, v7
  v_mul_f32 v165, v165, v7
  v_cvt_pk_bf16_f32 v8, v164, v165
  v_lshlrev_b32 v164, 16, v9
  v_and_b32 v165, 0xffff0000, v9
  v_sub_f32 v164, v164, v6
  v_sub_f32 v165, v165, v6
  v_cvt_pk_bf16_f32 v166, v164, v165
  v_lshlrev_b32 v164, 16, v166
  v_and_b32 v165, 0xffff0000, v166
  v_mul_f32 v164, v164, v7
  v_mul_f32 v165, v165, v7
  v_cvt_pk_bf16_f32 v9, v164, v165
  v_lshlrev_b32 v164, 16, v10
  v_and_b32 v165, 0xffff0000, v10
  v_sub_f32 v164, v164, v6
  v_sub_f32 v165, v165, v6
  v_cvt_pk_bf16_f32 v166, v164, v165
  v_lshlrev_b32 v164, 16, v166
  v_and_b32 v165, 0xffff0000, v166
  v_mul_f32 v164, v164, v7
  v_mul_f32 v165, v165, v7
  v_cvt_pk_bf16_f32 v10, v164, v165
  v_lshlrev_b32 v164, 16, v11
  v_and_b32 v165, 0xffff0000, v11
  v_sub_f32 v164, v164, v6
  v_sub_f32 v165, v165, v6
  v_cvt_pk_bf16_f32 v166, v164, v165
  v_lshlrev_b32 v164, 16, v166
  v_and_b32 v165, 0xffff0000, v166
  v_mul_f32 v164, v164, v7
  v_mul_f32 v165, v165, v7
  v_cvt_pk_bf16_f32 v11, v164, v165
  v_lshlrev_b32 v164, 16, v12
  v_and_b32 v165, 0xffff0000, v12
  v_sub_f32 v164, v164, v6
  v_sub_f32 v165, v165, v6
  v_cvt_pk_bf16_f32 v166, v164, v165
  v_lshlrev_b32 v164, 16, v166
  v_and_b32 v165, 0xffff0000, v166
  v_mul_f32 v164, v164, v7
  v_mul_f32 v165, v165, v7
  v_cvt_pk_bf16_f32 v12, v164, v165
  v_lshlrev_b32 v164, 16, v13
  v_and_b32 v165, 0xffff0000, v13
  v_sub_f32 v164, v164, v6
  v_sub_f32 v165, v165, v6
  v_cvt_pk_bf16_f32 v166, v164, v165
  v_lshlrev_b32 v164, 16, v166
  v_and_b32 v165, 0xffff0000, v166
  v_mul_f32 v164, v164, v7
  v_mul_f32 v165, v165, v7
  v_cvt_pk_bf16_f32 v13, v164, v165
  v_lshlrev_b32 v164, 16, v14
  v_and_b32 v165, 0xffff0000, v14
  v_sub_f32 v164, v164, v6
  v_sub_f32 v165, v165, v6
  v_cvt_pk_bf16_f32 v166, v164, v165
  v_lshlrev_b32 v164, 16, v166
  v_and_b32 v165, 0xffff0000, v166
  v_mul_f32 v164, v164, v7
  v_mul_f32 v165, v165, v7
  v_cvt_pk_bf16_f32 v14, v164, v165
  v_lshlrev_b32 v164, 16, v15
  v_and_b32 v165, 0xffff0000, v15
  v_sub_f32 v164, v164, v6
  v_sub_f32 v165, v165, v6
  v_cvt_pk_bf16_f32 v166, v164, v165
  v_lshlrev_b32 v164, 16, v166
  v_and_b32 v165, 0xffff0000, v166
  v_mul_f32 v164, v164, v7
  v_mul_f32 v165, v165, v7
  v_cvt_pk_bf16_f32 v15, v164, v165
  s_cmp_ge_u32 s3, 2
  s_cbranch_scc1 Lsk3_30
  v_lshlrev_b32 v164, 16, v16
  v_and_b32 v165, 0xffff0000, v16
  v_sub_f32 v164, v164, v6
  v_sub_f32 v165, v165, v6
  v_cvt_pk_bf16_f32 v166, v164, v165
  v_lshlrev_b32 v164, 16, v166
  v_and_b32 v165, 0xffff0000, v166
  v_mul_f32 v164, v164, v7
  v_mul_f32 v165, v165, v7
  v_cvt_pk_bf16_f32 v16, v164, v165
  v_lshlrev_b32 v164, 16, v17
  v_and_b32 v165, 0xffff0000, v17
  v_sub_f32 v164, v164, v6
  v_sub_f32 v165, v165, v6
  v_cvt_pk_bf16_f32 v166, v164, v165
  v_lshlrev_b32 v164, 16, v166
  v_and_b32 v165, 0xffff0000, v166
  v_mul_f32 v164, v164, v7
  v_mul_f32 v165, v165, v7
  v_cvt_pk_bf16_f32 v17, v164, v165
  v_lshlrev_b32 v164, 16, v18
  v_and_b32 v165, 0xffff0000, v18
  v_sub_f32 v164, v164, v6
  v_sub_f32 v165, v165, v6
  v_cvt_pk_bf16_f32 v166, v164, v165
  v_lshlrev_b32 v164, 16, v166
  v_and_b32 v165, 0xffff0000, v166
  v_mul_f32 v164, v164, v7
  v_mul_f32 v165, v165, v7
  v_cvt_pk_bf16_f32 v18, v164, v165
  v_lshlrev_b32 v164, 16, v19
  v_and_b32 v165, 0xffff0000, v19
  v_sub_f32 v164, v164, v6
  v_sub_f32 v165, v165, v6
  v_cvt_pk_bf16_f32 v166, v164, v165
  v_lshlrev_b32 v164, 16, v166
  v_and_b32 v165, 0xffff0000, v166
  v_mul_f32 v164, v164, v7
  v_mul_f32 v165, v165, v7
  v_cvt_pk_bf16_f32 v19, v164, v165
Lsk3_30:
  v_mov_b32 v165, 0
Lpoll_31:
  buffer_load_dword v164, v165, s[40:43], 0 offen sc1
  s_waitcnt vmcnt(0)
  v_cmp_eq_u32 vcc, 0, v164
  s_cbranch_vccz Lpd_32
  s_sleep 1
  s_add_u32 s30, s30, 1
  s_cmp_gt_u32 s30, 400000
  s_cbranch_scc0 Lpoll_31
Lpd_32:
  v_readfirstlane_b32 s31, v164
  s_nop 1
  v_lshrrev_b32 v7, 3, v2
  v_lshlrev_b32 v7, 7, v7
  v_lshl_add_u32 v7, v3, 8, v7
  v_lshl_add_u32 v7, v1, 5, v7
  s_lshl_b32 s56, s3, 11
  s_add_u32 s57, s56, 8192
  s_add_u32 s62, s56, 16384
  s_min_u32 s62, s62, 18432
  s_add_u32 s63, s56, 20480
  s_add_u32 s64, s57, 20480
  s_add_u32 s65, s62, 20480
Lpoll_33:
  buffer_load_dwordx4 v[20:23], v7, s[36:39], s56 offen sc1
  buffer_load_dwordx4 v[24:27], v7, s[36:39], s56 offen offset:16 sc1
  buffer_load_dwordx4 v[28:31], v7, s[36:39], s57 offen sc1
  buffer_load_dwordx4 v[32:35], v7, s[36:39], s57 offen offset:16 sc1
  buffer_load_dwordx4 v[36:39], v7, s[36:39], s62 offen sc1
  buffer_load_dwordx4 v[40:43], v7, s[36:39], s62 offen offset:16 sc1
  buffer_load_dwordx4 v[44:47], v7, s[36:39], s63 offen sc1
  buffer_load_dwordx4 v[48:51], v7, s[36:39], s63 offen offset:16 sc1
  buffer_load_dwordx4 v[52:55], v7, s[36:39], s64 offen sc1
  buffer_load_dwordx4 v[56:59], v7, s[36:39], s64 offen offset:16 sc1
  buffer_load_dwordx4 v[60:63], v7, s[36:39], s65 offen sc1
  buffer_load_dwordx4 v[64:67], v7, s[36:39], s65 offen offset:16 sc1
  s_waitcnt vmcnt(0)
  v_cmp_ne_u32 vcc, s31, v21
  v_cmp_ne_u32 s[58:59], s31, v25
  s_or_b64 vcc, vcc, s[58:59]
  v_cmp_ne_u32 s[58:59], s31, v29
  s_or_b64 vcc, vcc, s[58:59]
  v_cmp_ne_u32 s[58:59], s31, v33
  s_or_b64 vcc, vcc, s[58:59]
  v_cmp_ne_u32 s[58:59], s31, v37
  s_or_b64 vcc, vcc, s[58:59]
  v_cmp_ne_u32 s[58:59], s31, v41
  s_or_b64 vcc, vcc, s[58:59]
  v_cmp_ne_u32 s[58:59], s31, v45
  s_or_b64 vcc, vcc, s[58:59]
  v_cmp_ne_u32 s[58:59], s31, v49
  s_or_b64 vcc, vcc, s[58:59]
  v_cmp_ne_u32 s[58:59], s31, v53
  s_or_b64 vcc, vcc, s[58:59]
  v_cmp_ne_u32 s[58:59], s31, v57
  s_or_b64 vcc, vcc, s[58:59]
  v_cmp_ne_u32 s[58:59], s31, v61
  s_or_b64 vcc, vcc, s[58:59]
  v_cmp_ne_u32 s[58:59], s31, v65
  s_or_b64 vcc, vcc, s[58:59]
  s_cbranch_vccz Lpd_34
  s_sleep 1
  s_add_u32 s30, s30, 1
  s_cmp_gt_u32 s30, 400000
  s_cbranch_scc0 Lpoll_33
Lpd_34:
  v_lshlrev_b32 v164, 16, v8
  v_and_b32 v165, 0xffff0000, v8
  v_lshlrev_b32 v6, 16, v44
  v_and_b32 v7, 0xffff0000, v44
  v_add_f32 v6, 1.0, v6
  v_add_f32 v7, 1.0, v7
  v_cvt_pk_bf16_f32 v166, v6, v7
  v_lshlrev_b32 v6, 16, v166
  v_and_b32 v7, 0xffff0000, v166
  v_mul_f32 v164, v164, v6
  v_mul_f32 v165, v165, v7
  v_cvt_pk_bf16_f32 v166, v164, v165
  v_lshlrev_b32 v164, 16, v166
  v_and_b32 v165, 0xffff0000, v166
  v_lshlrev_b32 v6, 16, v20
  v_and_b32 v7, 0xffff0000, v20
  v_add_f32 v164, v164, v6
  v_add_f32 v165, v165, v7
  v_cvt_pk_bf16_f32 v8, v164, v165
  v_lshlrev_b32 v164, 16, v9
  v_and_b32 v165, 0xffff0000, v9
  v_lshlrev_b32 v6, 16, v46
  v_and_b32 v7, 0xffff0000, v46
  v_add_f32 v6, 1.0, v6
  v_add_f32 v7, 1.0, v7
  v_cvt_pk_bf16_f32 v166, v6, v7
  v_lshlrev_b32 v6, 16, v166
  v_and_b32 v7, 0xffff0000, v166
  v_mul_f32 v164, v164, v6
  v_mul_f32 v165, v165, v7
  v_cvt_pk_bf16_f32 v166, v164, v165
  v_lshlrev_b32 v164, 16, v166
  v_and_b32 v165, 0xffff0000, v166
  v_lshlrev_b32 v6, 16, v22
  v_and_b32 v7, 0xffff0000, v22
  v_add_f32 v164, v164, v6
  v_add_f32 v165, v165, v7
  v_cvt_pk_bf16_f32 v9, v164, v165
  v_lshlrev_b32 v164, 16, v10
  v_and_b32 v165, 0xffff0000, v10
  v_lshlrev_b32 v6, 16, v48
  v_and_b32 v7, 0xffff0000, v48
  v_add_f32 v6, 1.0, v6
  v_add_f32 v7, 1.0, v7
  v_cvt_pk_bf16_f32 v166, v6, v7
  v_lshlrev_b32 v6, 16, v166
  v_and_b32 v7, 0xffff0000, v166
  v_mul_f32 v164, v164, v6
  v_mul_f32 v165, v165, v7
  v_cvt_pk_bf16_f32 v166, v164, v165
  v_lshlrev_b32 v164, 16, v166
  v_and_b32 v165, 0xffff0000, v166
  v_lshlrev_b32 v6, 16, v24
  v_and_b32 v7, 0xffff0000, v24
  v_add_f32 v164, v164, v6
  v_add_f32 v165, v165, v7
  v_cvt_pk_bf16_f32 v10, v164, v165
  v_lshlrev_b32 v164, 16, v11
  v_and_b32 v165, 0xffff0000, v11
  v_lshlrev_b32 v6, 16, v50
  v_and_b32 v7, 0xffff0000, v50
  v_add_f32 v6, 1.0, v6
  v_add_f32 v7, 1.0, v7
  v_cvt_pk_bf16_f32 v166, v6, v7
  v_lshlrev_b32 v6, 16, v166
  v_and_b32 v7, 0xffff0000, v166
  v_mul_f32 v164, v164, v6
  v_mul_f32 v165, v165, v7
  v_cvt_pk_bf16_f32 v166, v164, v165
  v_lshlrev_b32 v164, 16, v166
  v_and_b32 v165, 0xffff0000, v166
  v_lshlrev_b32 v6, 16, v26
  v_and_b32 v7, 0xffff0000, v26
  v_add_f32 v164, v164, v6
  v_add_f32 v165, v165, v7
  v_cvt_pk_bf16_f32 v11, v164, v165
  v_lshlrev_b32 v164, 16, v12
  v_and_b32 v165, 0xffff0000, v12
  v_lshlrev_b32 v6, 16, v52
  v_and_b32 v7, 0xffff0000, v52
  v_add_f32 v6, 1.0, v6
  v_add_f32 v7, 1.0, v7
  v_cvt_pk_bf16_f32 v166, v6, v7
  v_lshlrev_b32 v6, 16, v166
  v_and_b32 v7, 0xffff0000, v166
  v_mul_f32 v164, v164, v6
  v_mul_f32 v165, v165, v7
  v_cvt_pk_bf16_f32 v166, v164, v165
  v_lshlrev_b32 v164, 16, v166
  v_and_b32 v165, 0xffff0000, v166
  v_lshlrev_b32 v6, 16, v28
  v_and_b32 v7, 0xffff0000, v28
  v_add_f32 v164, v164, v6
  v_add_f32 v165, v165, v7
  v_cvt_pk_bf16_f32 v12, v164, v165
  v_lshlrev_b32 v164, 16, v13
  v_and_b32 v165, 0xffff0000, v13
  v_lshlrev_b32 v6, 16, v54
  v_and_b32 v7, 0xffff0000, v54
  v_add_f32 v6, 1.0, v6
  v_add_f32 v7, 1.0, v7
  v_cvt_pk_bf16_f32 v166, v6, v7
  v_lshlrev_b32 v6, 16, v166
  v_and_b32 v7, 0xffff0000, v166
  v_mul_f32 v164, v164, v6
  v_mul_f32 v165, v165, v7
  v_cvt_pk_bf16_f32 v166, v164, v165
  v_lshlrev_b32 v164, 16, v166
  v_and_b32 v165, 0xffff0000, v166
  v_lshlrev_b32 v6, 16, v30
  v_and_b32 v7, 0xffff0000, v30
  v_add_f32 v164, v164, v6
  v_add_f32 v165, v165, v7
  v_cvt_pk_bf16_f32 v13, v164, v165
  v_lshlrev_b32 v164, 16, v14
  v_and_b32 v165, 0xffff0000, v14
  v_lshlrev_b32 v6, 16, v56
  v_and_b32 v7, 0xffff0000, v56
  v_add_f32 v6, 1.0, v6
  v_add_f32 v7, 1.0, v7
  v_cvt_pk_bf16_f32 v166, v6, v7
  v_lshlrev_b32 v6, 16, v166
  v_and_b32 v7, 0xffff0000, v166
  v_mul_f32 v164, v164, v6
  v_mul_f32 v165, v165, v7
  v_cvt_pk_bf16_f32 v166, v164, v165
  v_lshlrev_b32 v164, 16, v166
  v_and_b32 v165, 0xffff0000, v166
  v_lshlrev_b32 v6, 16, v32
  v_and_b32 v7, 0xffff0000, v32
  v_add_f32 v164, v164, v6
  v_add_f32 v165, v165, v7
  v_cvt_pk_bf16_f32 v14, v164, v165
  v_lshlrev_b32 v164, 16, v15
  v_and_b32 v165, 0xffff0000, v15
  v_lshlrev_b32 v6, 16, v58
  v_and_b32 v7, 0xffff0000, v58
  v_add_f32 v6, 1.0, v6
  v_add_f32 v7, 1.0, v7
  v_cvt_pk_bf16_f32 v166, v6, v7
  v_lshlrev_b32 v6, 16, v166
  v_and_b32 v7, 0xffff0000, v166
  v_mul_f32 v164, v164, v6
  v_mul_f32 v165, v165, v7
  v_cvt_pk_bf16_f32 v166, v164, v165
  v_lshlrev_b32 v164, 16, v166
  v_and_b32 v165, 0xffff0000, v166
  v_lshlrev_b32 v6, 16, v34
  v_and_b32 v7, 0xffff0000, v34
  v_add_f32 v164, v164, v6
  v_add_f32 v165, v165, v7
  v_cvt_pk_bf16_f32 v15, v164, v165
  s_cmp_ge_u32 s3, 2
  s_cbranch_scc1 Lsk3_35
  v_lshlrev_b32 v164, 16, v16
  v_and_b32 v165, 0xffff0000, v16
  v_lshlrev_b32 v6, 16, v60
  v_and_b32 v7, 0xffff0000, v60
  v_add_f32 v6, 1.0, v6
  v_add_f32 v7, 1.0, v7
  v_cvt_pk_bf16_f32 v166, v6, v7
  v_lshlrev_b32 v6, 16, v166
  v_and_b32 v7, 0xffff0000, v166
  v_mul_f32 v164, v164, v6
  v_mul_f32 v165, v165, v7
  v_cvt_pk_bf16_f32 v166, v164, v165
  v_lshlrev_b32 v164, 16, v166
  v_and_b32 v165, 0xffff0000, v166
  v_lshlrev_b32 v6, 16, v36
  v_and_b32 v7, 0xffff0000, v36
  v_add_f32 v164, v164, v6
  v_add_f32 v165, v165, v7
  v_cvt_pk_bf16_f32 v16, v164, v165
  v_lshlrev_b32 v164, 16, v17
  v_and_b32 v165, 0xffff0000, v17
  v_lshlrev_b32 v6, 16, v62
  v_and_b32 v7, 0xffff0000, v62
  v_add_f32 v6, 1.0, v6
  v_add_f32 v7, 1.0, v7
  v_cvt_pk_bf16_f32 v166, v6, v7
  v_lshlrev_b32 v6, 16, v166
  v_and_b32 v7, 0xffff0000, v166
  v_mul_f32 v164, v164, v6
  v_mul_f32 v165, v165, v7
  v_cvt_pk_bf16_f32 v166, v164, v165
  v_lshlrev_b32 v164, 16, v166
  v_and_b32 v165, 0xffff0000, v166
  v_lshlrev_b32 v6, 16, v38
  v_and_b32 v7, 0xffff0000, v38
  v_add_f32 v164, v164, v6
  v_add_f32 v165, v165, v7
  v_cvt_pk_bf16_f32 v17, v164, v165
  v_lshlrev_b32 v164, 16, v18
  v_and_b32 v165, 0xffff0000, v18
  v_lshlrev_b32 v6, 16, v64
  v_and_b32 v7, 0xffff0000, v64
  v_add_f32 v6, 1.0, v6
  v_add_f32 v7, 1.0, v7
  v_cvt_pk_bf16_f32 v166, v6, v7
  v_lshlrev_b32 v6, 16, v166
  v_and_b32 v7, 0xffff0000, v166
  v_mul_f32 v164, v164, v6
  v_mul_f32 v165, v165, v7
  v_cvt_pk_bf16_f32 v166, v164, v165
  v_lshlrev_b32 v164, 16, v166
  v_and_b32 v165, 0xffff0000, v166
  v_lshlrev_b32 v6, 16, v40
  v_and_b32 v7, 0xffff0000, v40
  v_add_f32 v164, v164, v6
  v_add_f32 v165, v165, v7
  v_cvt_pk_bf16_f32 v18, v164, v165
  v_lshlrev_b32 v164, 16, v19
  v_and_b32 v165, 0xffff0000, v19
  v_lshlrev_b32 v6, 16, v66
  v_and_b32 v7, 0xffff0000, v66
  v_add_f32 v6, 1.0, v6
  v_add_f32 v7, 1.0, v7
  v_cvt_pk_bf16_f32 v166, v6, v7
  v_lshlrev_b32 v6, 16, v166
  v_and_b32 v7, 0xffff0000, v166
  v_mul_f32 v164, v164, v6
  v_mul_f32 v165, v165, v7
  v_cvt_pk_bf16_f32 v166, v164, v165
  v_lshlrev_b32 v164, 16, v166
  v_and_b32 v165, 0xffff0000, v166
  v_lshlrev_b32 v6, 16, v42
  v_and_b32 v7, 0xffff0000, v42
  v_add_f32 v164, v164, v6
  v_add_f32 v165, v165, v7
  v_cvt_pk_bf16_f32 v19, v164, v165
Lsk3_35:
  v_perm_b32 v52, v70, v68, s60
  v_perm_b32 v56, v70, v68, s61
  v_perm_b32 v60, v71, v69, s60
  v_perm_b32 v64, v71, v69, s61
  v_perm_b32 v53, v74, v72, s60
  v_perm_b32 v57, v74, v72, s61
  v_perm_b32 v61, v75, v73, s60
  v_perm_b32 v65, v75, v73, s61
  v_perm_b32 v54, v78, v76, s60
  v_perm_b32 v58, v78, v76, s61
  v_perm_b32 v62, v79, v77, s60
  v_perm_b32 v66, v79, v77, s61
  v_perm_b32 v55, v82, v80, s60
  v_perm_b32 v59, v82, v80, s61
  v_perm_b32 v63, v83, v81, s60
  v_perm_b32 v67, v83, v81, s61
  s_nop 1
  v_mfma_f32_16x16x32_bf16 v[20:23], v[8:11], v[52:55], 0
  v_mfma_f32_16x16x32_bf16 v[24:27], v[8:11], v[56:59], 0
  v_mfma_f32_16x16x32_bf16 v[28:31], v[8:11], v[60:63], 0
  v_mfma_f32_16x16x32_bf16 v[32:35], v[8:11], v[64:67], 0
  v_perm_b32 v52, v86, v84, s60
  v_perm_b32 v56, v86, v84, s61
  v_perm_b32 v60, v87, v85, s60
  v_perm_b32 v64, v87, v85, s61
  v_perm_b32 v53, v90, v88, s60
  v_perm_b32 v57, v90, v88, s61
  v_perm_b32 v61, v91, v89, s60
  v_perm_b32 v65, v91, v89, s61
  v_perm_b32 v54, v94, v92, s60
  v_perm_b32 v58, v94, v92, s61
  v_perm_b32 v62, v95, v93, s60
  v_perm_b32 v66, v95, v93, s61
  v_perm_b32 v55, v98, v96, s60
  v_perm_b32 v59, v98, v96, s61
  v_perm_b32 v63, v99, v97, s60
  v_perm_b32 v67, v99, v97, s61
  s_nop 1
  v_mfma_f32_16x16x32_bf16 v[36:39], v[8:11], v[52:55], 0
  v_mfma_f32_16x16x32_bf16 v[40:43], v[8:11], v[56:59], 0
  v_mfma_f32_16x16x32_bf16 v[44:47], v[8:11], v[60:63], 0
  v_mfma_f32_16x16x32_bf16 v[48:51], v[8:11], v[64:67], 0
  v_perm_b32 v52, v102, v100, s60
  v_perm_b32 v56, v102, v100, s61
  v_perm_b32 v60, v103, v101, s60
  v_perm_b32 v64, v103, v101, s61
  v_perm_b32 v53, v106, v104, s60
  v_perm_b32 v57, v106, v104, s61
  v_perm_b32 v61, v107, v105, s60
  v_perm_b32 v65, v107, v105, s61
  v_perm_b32 v54, v110, v108, s60
  v_perm_b32 v58, v110, v108, s61
  v_perm_b32 v62, v111, v109, s60
  v_perm_b32 v66, v111, v109, s61
  v_perm_b32 v55, v114, v112, s60
  v_perm_b32 v59, v114, v112, s61
  v_perm_b32 v63, v115, v113, s60
  v_perm_b32 v67, v115, v113, s61
  s_nop 1
  v_mfma_f32_16x16x32_bf16 v[20:23], v[12:15], v[52:55], v[20:23]
  v_mfma_f32_16x16x32_bf16 v[24:27], v[12:15], v[56:59], v[24:27]
  v_mfma_f32_16x16x32_bf16 v[28:31], v[12:15], v[60:63], v[28:31]
  v_mfma_f32_16x16x32_bf16 v[32:35], v[12:15], v[64:67], v[32:35]
  v_perm_b32 v52, v118, v116, s60
  v_perm_b32 v56, v118, v116, s61
  v_perm_b32 v60, v119, v117, s60
  v_perm_b32 v64, v119, v117, s61
  v_perm_b32 v53, v122, v120, s60
  v_perm_b32 v57, v122, v120, s61
  v_perm_b32 v61, v123, v121, s60
  v_perm_b32 v65, v123, v121, s61
  v_perm_b32 v54, v126, v124, s60
  v_perm_b32 v58, v126, v124, s61
  v_perm_b32 v62, v127, v125, s60
  v_perm_b32 v66, v127, v125, s61
  v_perm_b32 v55, v130, v128, s60
  v_perm_b32 v59, v130, v128, s61
  v_perm_b32 v63, v131, v129, s60
  v_perm_b32 v67, v131, v129, s61
  s_nop 1
  v_mfma_f32_16x16x32_bf16 v[36:39], v[12:15], v[52:55], v[36:39]
  v_mfma_f32_16x16x32_bf16 v[40:43], v[12:15], v[56:59], v[40:43]
  v_mfma_f32_16x16x32_bf16 v[44:47], v[12:15], v[60:63], v[44:47]
  v_mfma_f32_16x16x32_bf16 v[48:51], v[12:15], v[64:67], v[48:51]
  s_cmp_ge_u32 s3, 2
  s_cbranch_scc1 Lsk3_36
  v_perm_b32 v52, v134, v132, s60
  v_perm_b32 v56, v134, v132, s61
  v_perm_b32 v60, v135, v133, s60
  v_perm_b32 v64, v135, v133, s61
  v_perm_b32 v53, v138, v136, s60
  v_perm_b32 v57, v138, v136, s61
  v_perm_b32 v61, v139, v137, s60
  v_perm_b32 v65, v139, v137, s61
  v_perm_b32 v54, v142, v140, s60
  v_perm_b32 v58, v142, v140, s61
  v_perm_b32 v62, v143, v141, s60
  v_perm_b32 v66, v143, v141, s61
  v_perm_b32 v55, v146, v144, s60
  v_perm_b32 v59, v146, v144, s61
  v_perm_b32 v63, v147, v145, s60
  v_perm_b32 v67, v147, v145, s61
  s_nop 1
  v_mfma_f32_16x16x32_bf16 v[20:23], v[16:19], v[52:55], v[20:23]
  v_mfma_f32_16x16x32_bf16 v[24:27], v[16:19], v[56:59], v[24:27]
  v_mfma_f32_16x16x32_bf16 v[28:31], v[16:19], v[60:63], v[28:31]
  v_mfma_f32_16x16x32_bf16 v[32:35], v[16:19], v[64:67], v[32:35]
  v_perm_b32 v52, v150, v148, s60
  v_perm_b32 v56, v150, v148, s61
  v_perm_b32 v60, v151, v149, s60
  v_perm_b32 v64, v151, v149, s61
  v_perm_b32 v53, v154, v152, s60
  v_perm_b32 v57, v154, v152, s61
  v_perm_b32 v61, v155, v153, s60
  v_perm_b32 v65, v155, v153, s61
  v_perm_b32 v54, v158, v156, s60
  v_perm_b32 v58, v158, v156, s61
  v_perm_b32 v62, v159, v157, s60
  v_perm_b32 v66, v159, v157, s61
  v_perm_b32 v55, v162, v160, s60
  v_perm_b32 v59, v162, v160, s61
  v_perm_b32 v63, v163, v161, s60
  v_perm_b32 v67, v163, v161, s61
  s_nop 1
  v_mfma_f32_16x16x32_bf16 v[36:39], v[16:19], v[52:55], v[36:39]
  v_mfma_f32_16x16x32_bf16 v[40:43], v[16:19], v[56:59], v[40:43]
  v_mfma_f32_16x16x32_bf16 v[44:47], v[16:19], v[60:63], v[44:47]
  v_mfma_f32_16x16x32_bf16 v[48:51], v[16:19], v[64:67], v[48:51]
Lsk3_36:
  v_lshrrev_b32 v6, 1, v1
  v_lshlrev_b32 v6, 11, v6
  v_and_b32 v7, 1, v1
  v_lshl_add_u32 v6, v7, 10, v6
  v_lshl_add_u32 v6, v2, 4, v6
  s_lshl_b32 s56, s3, 12
  v_add_u32 v6, s56, v6
  s_mov_b32 s58, 0
  s_mov_b32 s59, -1
  s_nop 2
  v_cndmask_b32 v68, v20, v36, s[58:59]
  v_cndmask_b32 v69, v24, v40, s[58:59]
  v_cndmask_b32 v70, v28, v44, s[58:59]
  v_cndmask_b32 v71, v32, v48, s[58:59]
  v_cndmask_b32 v72, v21, v37, s[58:59]
  v_cndmask_b32 v73, v25, v41, s[58:59]
  v_cndmask_b32 v74, v29, v45, s[58:59]
  v_cndmask_b32 v75, v33, v49, s[58:59]
  v_cndmask_b32 v76, v22, v38, s[58:59]
  v_cndmask_b32 v77, v26, v42, s[58:59]
  v_cndmask_b32 v78, v30, v46, s[58:59]
  v_cndmask_b32 v79, v34, v50, s[58:59]
  v_cndmask_b32 v80, v23, v39, s[58:59]
  v_cndmask_b32 v81, v27, v43, s[58:59]
  v_cndmask_b32 v82, v31, v47, s[58:59]
  v_cndmask_b32 v83, v35, v51, s[58:59]
  ds_write_b128 v6, v[68:71] offset:0
  ds_write_b128 v6, v[72:75] offset:256
  ds_write_b128 v6, v[76:79] offset:512
  ds_write_b128 v6, v[80:83] offset:768
  s_waitcnt lgkmcnt(0)
  v_mov_b32 v6, s31
  s_lshl_b32 s56, s3, 2
  v_mov_b32 v7, s56
  ds_write_b32 v7, v6 offset:16640
  s_cmp_ge_u32 s3, 2
  s_cbranch_scc1 Lpd__37
  v_mov_b32 v7, 0
Lpoll_38:
  ds_read_b128 v[20:23], v7 offset:16640
  s_waitcnt lgkmcnt(0)
  v_cmp_ne_u32 vcc, s31, v20
  v_cmp_ne_u32 s[58:59], s31, v21
  s_or_b64 vcc, vcc, s[58:59]
  v_cmp_ne_u32 s[58:59], s31, v22
  s_or_b64 vcc, vcc, s[58:59]
  v_cmp_ne_u32 s[58:59], s31, v23
  s_or_b64 vcc, vcc, s[58:59]
  s_cbranch_vccz Lpd_39
  s_add_u32 s30, s30, 1
  s_cmp_gt_u32 s30, 400000
  s_cbranch_scc0 Lpoll_38
Lpd_39:
  v_lshrrev_b32 v6, 3, v0
  v_lshlrev_b32 v6, 8, v6
  v_and_b32 v7, 7, v0
  v_lshl_add_u32 v6, v7, 4, v6
  s_lshl_b32 s56, s3, 7
  v_add_u32 v6, s56, v6
  ds_read_b128 v[20:23], v6 offset:0
  ds_read_b128 v[24:27], v6 offset:2048
  ds_read_b128 v[28:31], v6 offset:4096
  ds_read_b128 v[32:35], v6 offset:6144
  ds_read_b128 v[36:39], v6 offset:8192
  ds_read_b128 v[40:43], v6 offset:10240
  ds_read_b128 v[44:47], v6 offset:12288
  ds_read_b128 v[48:51], v6 offset:14336
  s_waitcnt lgkmcnt(0)
  v_add_f32 v20, v20, v24
  v_add_f32 v21, v21, v25
  v_add_f32 v22, v22, v26
  v_add_f32 v23, v23, v27
  v_add_f32 v28, v28, v32
  v_add_f32 v29, v29, v33
  v_add_f32 v30, v30, v34
  v_add_f32 v31, v31, v35
  v_add_f32 v36, v36, v40
  v_add_f32 v37, v37, v41
  v_add_f32 v38, v38, v42
  v_add_f32 v39, v39, v43
  v_add_f32 v44, v44, v48
  v_add_f32 v45, v45, v49
  v_add_f32 v46, v46, v50
  v_add_f32 v47, v47, v51
  v_add_f32 v20, v20, v28
  v_add_f32 v21, v21, v29
  v_add_f32 v22, v22, v30
  v_add_f32 v23, v23, v31
  v_add_f32 v36, v36, v44
  v_add_f32 v37, v37, v45
  v_add_f32 v38, v38, v46
  v_add_f32 v39, v39, v47
  v_add_f32 v8, v20, v36
  v_add_f32 v9, v21, v37
  v_add_f32 v10, v22, v38
  v_add_f32 v11, v23, v39
  v_cvt_pk_bf16_f32 v12, v8, v9
  v_cvt_pk_bf16_f32 v14, v10, v11
  v_mov_b32 v13, s31
  v_mov_b32 v15, s31
  s_lshl_b32 s56, s69, 11
  s_add_u32 s56, s56, 131072
  buffer_store_dwordx4 v[12:15], v6, s[36:39], s56 offen sc1
Lpd__37:
L_QWAIT:
  s_cmp_lg_u32 s3, 2
  s_cbranch_scc1 Lqd_40
  v_lshrrev_b32 v7, 5, v0
  v_lshlrev_b32 v7, 11, v7
  v_and_b32 v6, 31, v0
  v_lshl_add_u32 v7, v6, 3, v7
  s_lshl_b32 s56, s35, 12
  s_lshl_b32 s57, s34, 8
  s_add_u32 s56, s56, s57
  s_add_u32 s56, s56, 131072
Lpoll_41:
  buffer_load_dwordx2 v[8:9], v7, s[36:39], s56 offen sc1
  s_waitcnt vmcnt(0)
  v_cmp_ne_u32 vcc, s31, v9
  s_cbranch_vccz Lpd_42
  s_sleep 2
  s_add_u32 s30, s30, 1
  s_cmp_gt_u32 s30, 400000
  s_cbranch_scc0 Lpoll_41
Lpd_42:
  v_lshlrev_b32 v7, 2, v0
  v_mov_b32 v10, 24
  v_mov_b32 v11, 0
  ds_write_b32 v7, v8 offset:16384
  ds_write_b32 v11, v10 offset:16656
  s_waitcnt lgkmcnt(0)
  v_mov_b32 v10, 1
  ds_write_b32 v11, v10 offset:16664
Lqd_40:
  s_cmp_lg_u32 s3, 3
  s_cbranch_scc1 Lnoreset_43
  v_mov_b32 v8, -1
  v_mov_b32 v9, -1
  v_mov_b32 v10, -1
  v_mov_b32 v11, -1
  v_lshlrev_b32 v12, 2, v0
  v_lshlrev_b32 v13, 3, v0
  v_lshlrev_b32 v14, 4, v0
  s_lshl_b32 s56, s35, 3
  s_add_u32 s56, s56, s34
  s_lshl_b32 s56, s56, 8
  s_add_u32 s56, s56, 262144
  buffer_store_dword v8, v12, s[36:39], s56 offen sc1
  s_sub_u32 s56, s2, 184
  s_cmp_ge_u32 s56, 27
  s_cbranch_scc1 Lr_44
  s_lshl_b32 s56, s56, 10
  s_add_u32 s56, s56, 491520
  buffer_store_dwordx4 v[8:11], v14, s[36:39], s56 offen sc1
Lr_44:
  s_sub_u32 s56, s2, 211
  s_cmp_ge_u32 s56, 20
  s_cbranch_scc1 Lr_45
  s_lshl_b32 s56, s56, 9
  s_add_u32 s56, s56, 524288
  buffer_store_dwordx2 v[8:9], v13, s[36:39], s56 offen sc1
Lr_45:
  s_sub_u32 s56, s2, 104
  s_cmp_ge_u32 s56, 80
  s_cbranch_scc1 Lr_46
  s_lshl_b32 s56, s56, 11
  s_add_u32 s56, s56, 327680
  buffer_store_dwordx4 v[8:11], v14, s[36:39], s56 offen sc1
  buffer_store_dwordx4 v[8:11], v14, s[36:39], s56 offen offset:1024 sc1
Lr_46:
  s_waitcnt vmcnt(0)
  v_mov_b32 v9, 0
  v_mov_b32 v8, s31
  s_lshl_b32 s56, s2, 2
  s_add_u32 s56, s56, 520192
  s_mov_b64 s[58:59], exec
  s_mov_b64 exec, 1
  buffer_store_dword v8, v9, s[36:39], s56 offen sc1
  s_mov_b64 exec, s[58:59]
Lnoreset_43:
  s_cmp_ge_u32 s2, 231
  s_cbranch_scc1 L_WDONE
  s_cmp_ge_u32 s2, 211
  s_cbranch_scc1 L_W3
  s_cmp_ge_u32 s2, 184
  s_cbranch_scc1 L_W2
  s_cmp_lt_u32 s2, 104
  s_cbranch_scc1 L_WDONE
  s_sub_u32 s69, s2, 104
  s_mul_hi_u32 s66, s69, 429496730
  s_mul_i32 s67, s66, 10
  s_sub_u32 s67, s69, s67
  s_lshl_b32 s56, s67, 7
  s_add_u32 s44, s16, s56
  s_addc_u32 s45, s17, 0
  s_sub_u32 s46, 5242880, s56
  s_mov_b32 s47, 0x20000
  s_mov_b32 s57, 10240
  v_mul_lo_u32 v5, v1, s57
  v_lshl_add_u32 v5, v2, 3, v5
  s_lshl_b32 s56, s66, 3
  s_lshl_b32 s57, s3, 1
  s_add_u32 s56, s56, s57
  s_add_u32 s56, s56, 0
  s_mul_i32 s56, s56, 81920
  buffer_load_dwordx2 v[104:105], v5, s[44:47], s56 offen nt
  s_add_u32 s56, s56, 1280
  buffer_load_dwordx2 v[106:107], v5, s[44:47], s56 offen nt
  s_add_u32 s56, s56, 1280
  buffer_load_dwordx2 v[108:109], v5, s[44:47], s56 offen nt
  s_add_u32 s56, s56, 1280
  buffer_load_dwordx2 v[110:111], v5, s[44:47], s56 offen nt
  s_add_u32 s56, s56, 1280
  buffer_load_dwordx2 v[112:113], v5, s[44:47], s56 offen nt
  s_add_u32 s56, s56, 1280
  buffer_load_dwordx2 v[114:115], v5, s[44:47], s56 offen nt
  s_add_u32 s56, s56, 1280
  buffer_load_dwordx2 v[116:117], v5, s[44:47], s56 offen nt
  s_add_u32 s56, s56, 1280
  buffer_load_dwordx2 v[118:119], v5, s[44:47], s56 offen nt
  s_add_u32 s56, s56, 32000
  buffer_load_dwordx2 v[120:121], v5, s[44:47], s56 offen nt
  s_add_u32 s56, s56, 1280
  buffer_load_dwordx2 v[122:123], v5, s[44:47], s56 offen nt
  s_add_u32 s56, s56, 1280
  buffer_load_dwordx2 v[124:125], v5, s[44:47], s56 offen nt
  s_add_u32 s56, s56, 1280
  buffer_load_dwordx2 v[126:127], v5, s[44:47], s56 offen nt
  s_add_u32 s56, s56, 1280
  buffer_load_dwordx2 v[128:129], v5, s[44:47], s56 offen nt
  s_add_u32 s56, s56, 1280
  buffer_load_dwordx2 v[130:131], v5, s[44:47], s56 offen nt
  s_add_u32 s56, s56, 1280
  buffer_load_dwordx2 v[132:133], v5, s[44:47], s56 offen nt
  s_add_u32 s56, s56, 1280
  buffer_load_dwordx2 v[134:135], v5, s[44:47], s56 offen nt
  s_lshl_b32 s56, s66, 3
  s_lshl_b32 s57, s3, 1
  s_add_u32 s56, s56, s57
  s_add_u32 s56, s56, 1
  s_mul_i32 s56, s56, 81920
  buffer_load_dwordx2 v[136:137], v5, s[44:47], s56 offen nt
  s_add_u32 s56, s56, 1280
  buffer_load_dwordx2 v[138:139], v5, s[44:47], s56 offen nt
  s_add_u32 s56, s56, 1280
  buffer_load_dwordx2 v[140:141], v5, s[44:47], s56 offen nt
  s_add_u32 s56, s56, 1280
  buffer_load_dwordx2 v[142:143], v5, s[44:47], s56 offen nt
  s_add_u32 s56, s56, 1280
  buffer_load_dwordx2 v[144:145], v5, s[44:47], s56 offen nt
  s_add_u32 s56, s56, 1280
  buffer_load_dwordx2 v[146:147], v5, s[44:47], s56 offen nt
  s_add_u32 s56, s56, 1280
  buffer_load_dwordx2 v[148:149], v5, s[44:47], s56 offen nt
  s_add_u32 s56, s56, 1280
  buffer_load_dwordx2 v[150:151], v5, s[44:47], s56 offen nt
  s_add_u32 s56, s56, 32000
  buffer_load_dwordx2 v[152:153], v5, s[44:47], s56 offen nt
  s_add_u32 s56, s56, 1280
  buffer_load_dwordx2 v[154:155], v5, s[44:47], s56 offen nt
  s_add_u32 s56, s56, 1280
  buffer_load_dwordx2 v[156:157], v5, s[44:47], s56 offen nt
  s_add_u32 s56, s56, 1280
  buffer_load_dwordx2 v[158:159], v5, s[44:47], s56 offen nt
  s_add_u32 s56, s56, 1280
  buffer_load_dwordx2 v[160:161], v5, s[44:47], s56 offen nt
  s_add_u32 s56, s56, 1280
  buffer_load_dwordx2 v[162:163], v5, s[44:47], s56 offen nt
  s_add_u32 s56, s56, 1280
  buffer_load_dwordx2 v[164:165], v5, s[44:47], s56 offen nt
  s_add_u32 s56, s56, 1280
  buffer_load_dwordx2 v[166:167], v5, s[44:47], s56 offen nt
  s_waitcnt vmcnt(0)
  v_perm_b32 v40, v106, v104, s60
  v_perm_b32 v44, v106, v104, s61
  v_perm_b32 v48, v107, v105, s60
  v_perm_b32 v52, v107, v105, s61
  v_perm_b32 v41, v110, v108, s60
  v_perm_b32 v45, v110, v108, s61
  v_perm_b32 v49, v111, v109, s60
  v_perm_b32 v53, v111, v109, s61
  v_perm_b32 v42, v114, v112, s60
  v_perm_b32 v46, v114, v112, s61
  v_perm_b32 v50, v115, v113, s60
  v_perm_b32 v54, v115, v113, s61
  v_perm_b32 v43, v118, v116, s60
  v_perm_b32 v47, v118, v116, s61
  v_perm_b32 v51, v119, v117, s60
  v_perm_b32 v55, v119, v117, s61
  v_perm_b32 v56, v122, v120, s60
  v_perm_b32 v60, v122, v120, s61
  v_perm_b32 v64, v123, v121, s60
  v_perm_b32 v68, v123, v121, s61
  v_perm_b32 v57, v126, v124, s60
  v_perm_b32 v61, v126, v124, s61
  v_perm_b32 v65, v127, v125, s60
  v_perm_b32 v69, v127, v125, s61
  v_perm_b32 v58, v130, v128, s60
  v_perm_b32 v62, v130, v128, s61
  v_perm_b32 v66, v131, v129, s60
  v_perm_b32 v70, v131, v129, s61
  v_perm_b32 v59, v134, v132, s60
  v_perm_b32 v63, v134, v132, s61
  v_perm_b32 v67, v135, v133, s60
  v_perm_b32 v71, v135, v133, s61
  v_perm_b32 v72, v138, v136, s60
  v_perm_b32 v76, v138, v136, s61
  v_perm_b32 v80, v139, v137, s60
  v_perm_b32 v84, v139, v137, s61
  v_perm_b32 v73, v142, v140, s60
  v_perm_b32 v77, v142, v140, s61
  v_perm_b32 v81, v143, v141, s60
  v_perm_b32 v85, v143, v141, s61
  v_perm_b32 v74, v146, v144, s60
  v_perm_b32 v78, v146, v144, s61
  v_perm_b32 v82, v147, v145, s60
  v_perm_b32 v86, v147, v145, s61
  v_perm_b32 v75, v150, v148, s60
  v_perm_b32 v79, v150, v148, s61
  v_perm_b32 v83, v151, v149, s60
  v_perm_b32 v87, v151, v149, s61
  v_perm_b32 v88, v154, v152, s60
  v_perm_b32 v92, v154, v152, s61
  v_perm_b32 v96, v155, v153, s60
  v_perm_b32 v100, v155, v153, s61
  v_perm_b32 v89, v158, v156, s60
  v_perm_b32 v93, v158, v156, s61
  v_perm_b32 v97, v159, v157, s60
  v_perm_b32 v101, v159, v157, s61
  v_perm_b32 v90, v162, v160, s60
  v_perm_b32 v94, v162, v160, s61
  v_perm_b32 v98, v163, v161, s60
  v_perm_b32 v102, v163, v161, s61
  v_perm_b32 v91, v166, v164, s60
  v_perm_b32 v95, v166, v164, s61
  v_perm_b32 v99, v167, v165, s60
  v_perm_b32 v103, v167, v165, s61
  s_cmp_lg_u32 s3, 0
  s_cbranch_scc1 Lnordy_47
  v_lshlrev_b32 v12, 4, v0
  s_mov_b32 s56, 520192
Lpoll_48:
  buffer_load_dwordx4 v[8:11], v12, s[36:39], s56 offen sc1
  s_waitcnt vmcnt(0)
  v_cmp_ne_u32 vcc, s31, v8
  v_cmp_ne_u32 s[58:59], s31, v9
  s_or_b64 vcc, vcc, s[58:59]
  v_cmp_ne_u32 s[58:59], s31, v10
  s_or_b64 vcc, vcc, s[58:59]
  v_cmp_ne_u32 s[58:59], s31, v11
  s_or_b64 vcc, vcc, s[58:59]
  s_cbranch_vccz Lpd_49
  s_sleep 100
  s_add_u32 s30, s30, 1
  s_cmp_gt_u32 s30, 400000
  s_cbranch_scc0 Lpoll_48
Lpd_49:
Lnordy_47:
  s_branch L_WDONE
L_W2:
  s_mov_b32 s68, s3
  s_sub_u32 s57, s2, 184
  s_lshl_b32 s56, s57, 7
  s_add_u32 s44, s20, s56
  s_addc_u32 s45, s21, 0
  s_sub_u32 s46, 2211840, s56
  s_mov_b32 s47, 0x20000
  s_mov_b32 s57, 27648
  v_mul_lo_u32 v5, v1, s57
  v_lshl_add_u32 v5, v2, 3, v5
  s_mul_i32 s56, s68, 221184
  buffer_load_dwordx2 v[8:9], v5, s[44:47], s56 offen nt
  s_add_u32 s56, s56, 3456
  buffer_load_dwordx2 v[10:11], v5, s[44:47], s56 offen nt
  s_add_u32 s56, s56, 3456
  buffer_load_dwordx2 v[12:13], v5, s[44:47], s56 offen nt
  s_add_u32 s56, s56, 3456
  buffer_load_dwordx2 v[14:15], v5, s[44:47], s56 offen nt
  s_add_u32 s56, s56, 3456
  buffer_load_dwordx2 v[16:17], v5, s[44:47], s56 offen nt
  s_add_u32 s56, s56, 3456
  buffer_load_dwordx2 v[18:19], v5, s[44:47], s56 offen nt
  s_add_u32 s56, s56, 3456
  buffer_load_dwordx2 v[20:21], v5, s[44:47], s56 offen nt
  s_add_u32 s56, s56, 3456
  buffer_load_dwordx2 v[22:23], v5, s[44:47], s56 offen nt
  s_add_u32 s56, s56, 86400
  buffer_load_dwordx2 v[24:25], v5, s[44:47], s56 offen nt
  s_add_u32 s56, s56, 3456
  buffer_load_dwordx2 v[26:27], v5, s[44:47], s56 offen nt
  s_add_u32 s56, s56, 3456
  buffer_load_dwordx2 v[28:29], v5, s[44:47], s56 offen nt
  s_add_u32 s56, s56, 3456
  buffer_load_dwordx2 v[30:31], v5, s[44:47], s56 offen nt
  s_add_u32 s56, s56, 3456
  buffer_load_dwordx2 v[32:33], v5, s[44:47], s56 offen nt
  s_add_u32 s56, s56, 3456
  buffer_load_dwordx2 v[34:35], v5, s[44:47], s56 offen nt
  s_add_u32 s56, s56, 3456
  buffer_load_dwordx2 v[36:37], v5, s[44:47], s56 offen nt
  s_add_u32 s56, s56, 3456
  buffer_load_dwordx2 v[38:39], v5, s[44:47], s56 offen nt
  v_lshrrev_b32 v7, 3, v2
  v_lshlrev_b32 v7, 7, v7
  v_lshl_add_u32 v7, v3, 8, v7
  v_lshl_add_u32 v7, v1, 5, v7
  s_lshl_b32 s56, s68, 11
Lpoll_50:
  s_add_u32 s57, s56, 61440
  buffer_load_dwordx4 v[72:75], v7, s[36:39], s57 offen sc1
  buffer_load_dwordx4 v[76:79], v7, s[36:39], s57 offen offset:16 sc1
  s_add_u32 s57, s56, 81920
  buffer_load_dwordx4 v[80:83], v7, s[36:39], s57 offen sc1
  buffer_load_dwordx4 v[84:87], v7, s[36:39], s57 offen offset:16 sc1
  s_waitcnt vmcnt(0)
  v_cmp_ne_u32 vcc, s31, v73
  v_cmp_ne_u32 s[58:59], s31, v77
  s_or_b64 vcc, vcc, s[58:59]
  v_cmp_ne_u32 s[58:59], s31, v81
  s_or_b64 vcc, vcc, s[58:59]
  v_cmp_ne_u32 s[58:59], s31, v85
  s_or_b64 vcc, vcc, s[58:59]
  s_cbranch_vccz Lpd_51
  s_sleep 100
  s_add_u32 s30, s30, 1
  s_cmp_gt_u32 s30, 400000
  s_cbranch_scc0 Lpoll_50
Lpd_51:
  v_perm_b32 v40, v10, v8, s60
  v_perm_b32 v44, v10, v8, s61
  v_perm_b32 v48, v11, v9, s60
  v_perm_b32 v52, v11, v9, s61
  v_perm_b32 v41, v14, v12, s60
  v_perm_b32 v45, v14, v12, s61
  v_perm_b32 v49, v15, v13, s60
  v_perm_b32 v53, v15, v13, s61
  v_perm_b32 v42, v18, v16, s60
  v_perm_b32 v46, v18, v16, s61
  v_perm_b32 v50, v19, v17, s60
  v_perm_b32 v54, v19, v17, s61
  v_perm_b32 v43, v22, v20, s60
  v_perm_b32 v47, v22, v20, s61
  v_perm_b32 v51, v23, v21, s60
  v_perm_b32 v55, v23, v21, s61
  v_perm_b32 v56, v26, v24, s60
  v_perm_b32 v60, v26, v24, s61
  v_perm_b32 v64, v27, v25, s60
  v_perm_b32 v68, v27, v25, s61
  v_perm_b32 v57, v30, v28, s60
  v_perm_b32 v61, v30, v28, s61
  v_perm_b32 v65, v31, v29, s60
  v_perm_b32 v69, v31, v29, s61
  v_perm_b32 v58, v34, v32, s60
  v_perm_b32 v62, v34, v32, s61
  v_perm_b32 v66, v35, v33, s60
  v_perm_b32 v70, v35, v33, s61
  v_perm_b32 v59, v38, v36, s60
  v_perm_b32 v63, v38, v36, s61
  v_perm_b32 v67, v39, v37, s60
  v_perm_b32 v71, v39, v37, s61
  v_lshlrev_b32 v100, 16, v72
  v_and_b32 v101, 0xffff0000, v72
  v_lshlrev_b32 v108, 16, v80
  v_and_b32 v109, 0xffff0000, v80
  v_add_f32 v108, 1.0, v108
  v_add_f32 v109, 1.0, v109
  v_cvt_pk_bf16_f32 v8, v108, v109
  v_lshlrev_b32 v108, 16, v8
  v_and_b32 v109, 0xffff0000, v8
  v_lshlrev_b32 v102, 16, v74
  v_and_b32 v103, 0xffff0000, v74
  v_lshlrev_b32 v110, 16, v82
  v_and_b32 v111, 0xffff0000, v82
  v_add_f32 v110, 1.0, v110
  v_add_f32 v111, 1.0, v111
  v_cvt_pk_bf16_f32 v8, v110, v111
  v_lshlrev_b32 v110, 16, v8
  v_and_b32 v111, 0xffff0000, v8
  v_lshlrev_b32 v104, 16, v76
  v_and_b32 v105, 0xffff0000, v76
  v_lshlrev_b32 v112, 16, v84
  v_and_b32 v113, 0xffff0000, v84
  v_add_f32 v112, 1.0, v112
  v_add_f32 v113, 1.0, v113
  v_cvt_pk_bf16_f32 v8, v112, v113
  v_lshlrev_b32 v112, 16, v8
  v_and_b32 v113, 0xffff0000, v8
  v_lshlrev_b32 v106, 16, v78
  v_and_b32 v107, 0xffff0000, v78
  v_lshlrev_b32 v114, 16, v86
  v_and_b32 v115, 0xffff0000, v86
  v_add_f32 v114, 1.0, v114
  v_add_f32 v115, 1.0, v115
  v_cvt_pk_bf16_f32 v8, v114, v115
  v_lshlrev_b32 v114, 16, v8
  v_and_b32 v115, 0xffff0000, v8
  v_lshrrev_b32 v4, 3, v2
  v_lshlrev_b32 v4, 9, v4
  v_lshl_add_u32 v4, v3, 6, v4
  v_lshl_add_u32 v4, v1, 4, v4
  s_cmp_lg_u32 s3, 0
  s_cbranch_scc1 Lnordy_52
  v_lshlrev_b32 v156, 4, v0
  s_mov_b32 s56, 520192
Lpoll_53:
  buffer_load_dwordx4 v[152:155], v156, s[36:39], s56 offen sc1
  s_waitcnt vmcnt(0)
  v_cmp_ne_u32 vcc, s31, v152
  v_cmp_ne_u32 s[58:59], s31, v153
  s_or_b64 vcc, vcc, s[58:59]
  v_cmp_ne_u32 s[58:59], s31, v154
  s_or_b64 vcc, vcc, s[58:59]
  v_cmp_ne_u32 s[58:59], s31, v155
  s_or_b64 vcc, vcc, s[58:59]
  s_cbranch_vccz Lpd_54
  s_sleep 100
  s_add_u32 s30, s30, 1
  s_cmp_gt_u32 s30, 400000
  s_cbranch_scc0 Lpoll_53
Lpd_54:
Lnordy_52:
  s_cmp_lg_u32 s3, 3
  s_cbranch_scc1 Lz_55
  v_mov_b32 v8, s31
  v_mov_b32 v6, 0
  ds_write_b32 v6, v8 offset:16660
  s_waitcnt lgkmcnt(0)
Lz_55:
  s_branch L_WDONE
L_W3:
  s_sub_u32 s57, s2, 211
  s_lshl_b32 s56, s57, 6
  s_add_u32 s44, s22, s56
  s_addc_u32 s45, s23, 0
  s_sub_u32 s46, 2211840, s56
  s_mov_b32 s47, 0x20000
  s_movk_i32 s57, 10240
  v_mul_lo_u32 v5, v1, s57
  v_lshl_add_u32 v5, v2, 2, v5
  s_add_u32 s56, s3, 0
  s_mul_i32 s56, s56, 81920
  buffer_load_dword v8, v5, s[44:47], s56 offen nt
  s_add_u32 s56, s56, 1280
  buffer_load_dword v12, v5, s[44:47], s56 offen nt
  s_add_u32 s56, s56, 1280
  buffer_load_dword v9, v5, s[44:47], s56 offen nt
  s_add_u32 s56, s56, 1280
  buffer_load_dword v13, v5, s[44:47], s56 offen nt
  s_add_u32 s56, s56, 1280
  buffer_load_dword v10, v5, s[44:47], s56 offen nt
  s_add_u32 s56, s56, 1280
  buffer_load_dword v14, v5, s[44:47], s56 offen nt
  s_add_u32 s56, s56, 1280
  buffer_load_dword v11, v5, s[44:47], s56 offen nt
  s_add_u32 s56, s56, 1280
  buffer_load_dword v15, v5, s[44:47], s56 offen nt
  s_add_u32 s56, s56, 32000
  buffer_load_dword v16, v5, s[44:47], s56 offen nt
  s_add_u32 s56, s56, 1280
  buffer_load_dword v20, v5, s[44:47], s56 offen nt
  s_add_u32 s56, s56, 1280
  buffer_load_dword v17, v5, s[44:47], s56 offen nt
  s_add_u32 s56, s56, 1280
  buffer_load_dword v21, v5, s[44:47], s56 offen nt
  s_add_u32 s56, s56, 1280
  buffer_load_dword v18, v5, s[44:47], s56 offen nt
  s_add_u32 s56, s56, 1280
  buffer_load_dword v22, v5, s[44:47], s56 offen nt
  s_add_u32 s56, s56, 1280
  buffer_load_dword v19, v5, s[44:47], s56 offen nt
  s_add_u32 s56, s56, 1280
  buffer_load_dword v23, v5, s[44:47], s56 offen nt
  s_add_u32 s56, s56, 32000
  s_add_u32 s56, s3, 4
  s_mul_i32 s56, s56, 81920
  buffer_load_dword v24, v5, s[44:47], s56 offen nt
  s_add_u32 s56, s56, 1280
  buffer_load_dword v28, v5, s[44:47], s56 offen nt
  s_add_u32 s56, s56, 1280
  buffer_load_dword v25, v5, s[44:47], s56 offen nt
  s_add_u32 s56, s56, 1280
  buffer_load_dword v29, v5, s[44:47], s56 offen nt
  s_add_u32 s56, s56, 1280
  buffer_load_dword v26, v5, s[44:47], s56 offen nt
  s_add_u32 s56, s56, 1280
  buffer_load_dword v30, v5, s[44:47], s56 offen nt
  s_add_u32 s56, s56, 1280
  buffer_load_dword v27, v5, s[44:47], s56 offen nt
  s_add_u32 s56, s56, 1280
  buffer_load_dword v31, v5, s[44:47], s56 offen nt
  s_add_u32 s56, s56, 32000
  buffer_load_dword v32, v5, s[44:47], s56 offen nt
  s_add_u32 s56, s56, 1280
  buffer_load_dword v36, v5, s[44:47], s56 offen nt
  s_add_u32 s56, s56, 1280
  buffer_load_dword v33, v5, s[44:47], s56 offen nt
  s_add_u32 s56, s56, 1280
  buffer_load_dword v37, v5, s[44:47], s56 offen nt
  s_add_u32 s56, s56, 1280
  buffer_load_dword v34, v5, s[44:47], s56 offen nt
  s_add_u32 s56, s56, 1280
  buffer_load_dword v38, v5, s[44:47], s56 offen nt
  s_add_u32 s56, s56, 1280
  buffer_load_dword v35, v5, s[44:47], s56 offen nt
  s_add_u32 s56, s56, 1280
  buffer_load_dword v39, v5, s[44:47], s56 offen nt
  s_add_u32 s56, s56, 32000
  s_waitcnt vmcnt(0)
  v_perm_b32 v40, v12, v8, s60
  v_perm_b32 v44, v12, v8, s61
  v_perm_b32 v41, v13, v9, s60
  v_perm_b32 v45, v13, v9, s61
  v_perm_b32 v42, v14, v10, s60
  v_perm_b32 v46, v14, v10, s61
  v_perm_b32 v43, v15, v11, s60
  v_perm_b32 v47, v15, v11, s61
  v_perm_b32 v48, v20, v16, s60
  v_perm_b32 v52, v20, v16, s61
  v_perm_b32 v49, v21, v17, s60
  v_perm_b32 v53, v21, v17, s61
  v_perm_b32 v50, v22, v18, s60
  v_perm_b32 v54, v22, v18, s61
  v_perm_b32 v51, v23, v19, s60
  v_perm_b32 v55, v23, v19, s61
  v_perm_b32 v56, v28, v24, s60
  v_perm_b32 v60, v28, v24, s61
  v_perm_b32 v57, v29, v25, s60
  v_perm_b32 v61, v29, v25, s61
  v_perm_b32 v58, v30, v26, s60
  v_perm_b32 v62, v30, v26, s61
  v_perm_b32 v59, v31, v27, s60
  v_perm_b32 v63, v31, v27, s61
  v_perm_b32 v64, v36, v32, s60
  v_perm_b32 v68, v36, v32, s61
  v_perm_b32 v65, v37, v33, s60
  v_perm_b32 v69, v37, v33, s61
  v_perm_b32 v66, v38, v34, s60
  v_perm_b32 v70, v38, v34, s61
  v_perm_b32 v67, v39, v35, s60
  v_perm_b32 v71, v39, v35, s61
  s_add_u32 s56, s3, 8
  s_mul_i32 s56, s56, 81920
  buffer_load_dword v8, v5, s[44:47], s56 offen nt
  s_add_u32 s56, s56, 1280
  buffer_load_dword v12, v5, s[44:47], s56 offen nt
  s_add_u32 s56, s56, 1280
  buffer_load_dword v9, v5, s[44:47], s56 offen nt
  s_add_u32 s56, s56, 1280
  buffer_load_dword v13, v5, s[44:47], s56 offen nt
  s_add_u32 s56, s56, 1280
  buffer_load_dword v10, v5, s[44:47], s56 offen nt
  s_add_u32 s56, s56, 1280
  buffer_load_dword v14, v5, s[44:47], s56 offen nt
  s_add_u32 s56, s56, 1280
  buffer_load_dword v11, v5, s[44:47], s56 offen nt
  s_add_u32 s56, s56, 1280
  buffer_load_dword v15, v5, s[44:47], s56 offen nt
  s_add_u32 s56, s56, 32000
  buffer_load_dword v16, v5, s[44:47], s56 offen nt
  s_add_u32 s56, s56, 1280
  buffer_load_dword v20, v5, s[44:47], s56 offen nt
  s_add_u32 s56, s56, 1280
  buffer_load_dword v17, v5, s[44:47], s56 offen nt
  s_add_u32 s56, s56, 1280
  buffer_load_dword v21, v5, s[44:47], s56 offen nt
  s_add_u32 s56, s56, 1280
  buffer_load_dword v18, v5, s[44:47], s56 offen nt
  s_add_u32 s56, s56, 1280
  buffer_load_dword v22, v5, s[44:47], s56 offen nt
  s_add_u32 s56, s56, 1280
  buffer_load_dword v19, v5, s[44:47], s56 offen nt
  s_add_u32 s56, s56, 1280
  buffer_load_dword v23, v5, s[44:47], s56 offen nt
  s_add_u32 s56, s56, 32000
  s_add_u32 s56, s3, 12
  s_mul_i32 s56, s56, 81920
  buffer_load_dword v24, v5, s[44:47], s56 offen nt
  s_add_u32 s56, s56, 1280
  buffer_load_dword v28, v5, s[44:47], s56 offen nt
  s_add_u32 s56, s56, 1280
  buffer_load_dword v25, v5, s[44:47], s56 offen nt
  s_add_u32 s56, s56, 1280
  buffer_load_dword v29, v5, s[44:47], s56 offen nt
  s_add_u32 s56, s56, 1280
  buffer_load_dword v26, v5, s[44:47], s56 offen nt
  s_add_u32 s56, s56, 1280
  buffer_load_dword v30, v5, s[44:47], s56 offen nt
  s_add_u32 s56, s56, 1280
  buffer_load_dword v27, v5, s[44:47], s56 offen nt
  s_add_u32 s56, s56, 1280
  buffer_load_dword v31, v5, s[44:47], s56 offen nt
  s_add_u32 s56, s56, 32000
  buffer_load_dword v32, v5, s[44:47], s56 offen nt
  s_add_u32 s56, s56, 1280
  buffer_load_dword v36, v5, s[44:47], s56 offen nt
  s_add_u32 s56, s56, 1280
  buffer_load_dword v33, v5, s[44:47], s56 offen nt
  s_add_u32 s56, s56, 1280
  buffer_load_dword v37, v5, s[44:47], s56 offen nt
  s_add_u32 s56, s56, 1280
  buffer_load_dword v34, v5, s[44:47], s56 offen nt
  s_add_u32 s56, s56, 1280
  buffer_load_dword v38, v5, s[44:47], s56 offen nt
  s_add_u32 s56, s56, 1280
  buffer_load_dword v35, v5, s[44:47], s56 offen nt
  s_add_u32 s56, s56, 1280
  buffer_load_dword v39, v5, s[44:47], s56 offen nt
  s_add_u32 s56, s56, 32000
  s_waitcnt vmcnt(0)
  v_perm_b32 v72, v12, v8, s60
  v_perm_b32 v76, v12, v8, s61
  v_perm_b32 v73, v13, v9, s60
  v_perm_b32 v77, v13, v9, s61
  v_perm_b32 v74, v14, v10, s60
  v_perm_b32 v78, v14, v10, s61
  v_perm_b32 v75, v15, v11, s60
  v_perm_b32 v79, v15, v11, s61
  v_perm_b32 v80, v20, v16, s60
  v_perm_b32 v84, v20, v16, s61
  v_perm_b32 v81, v21, v17, s60
  v_perm_b32 v85, v21, v17, s61
  v_perm_b32 v82, v22, v18, s60
  v_perm_b32 v86, v22, v18, s61
  v_perm_b32 v83, v23, v19, s60
  v_perm_b32 v87, v23, v19, s61
  v_perm_b32 v88, v28, v24, s60
  v_perm_b32 v92, v28, v24, s61
  v_perm_b32 v89, v29, v25, s60
  v_perm_b32 v93, v29, v25, s61
  v_perm_b32 v90, v30, v26, s60
  v_perm_b32 v94, v30, v26, s61
  v_perm_b32 v91, v31, v27, s60
  v_perm_b32 v95, v31, v27, s61
  v_perm_b32 v96, v36, v32, s60
  v_perm_b32 v100, v36, v32, s61
  v_perm_b32 v97, v37, v33, s60
  v_perm_b32 v101, v37, v33, s61
  v_perm_b32 v98, v38, v34, s60
  v_perm_b32 v102, v38, v34, s61
  v_perm_b32 v99, v39, v35, s60
  v_perm_b32 v103, v39, v35, s61
  s_add_u32 s56, s3, 16
  s_mul_i32 s56, s56, 81920
  buffer_load_dword v8, v5, s[44:47], s56 offen nt
  s_add_u32 s56, s56, 1280
  buffer_load_dword v12, v5, s[44:47], s56 offen nt
  s_add_u32 s56, s56, 1280
  buffer_load_dword v9, v5, s[44:47], s56 offen nt
  s_add_u32 s56, s56, 1280
  buffer_load_dword v13, v5, s[44:47], s56 offen nt
  s_add_u32 s56, s56, 1280
  buffer_load_dword v10, v5, s[44:47], s56 offen nt
  s_add_u32 s56, s56, 1280
  buffer_load_dword v14, v5, s[44:47], s56 offen nt
  s_add_u32 s56, s56, 1280
  buffer_load_dword v11, v5, s[44:47], s56 offen nt
  s_add_u32 s56, s56, 1280
  buffer_load_dword v15, v5, s[44:47], s56 offen nt
  s_add_u32 s56, s56, 32000
  buffer_load_dword v16, v5, s[44:47], s56 offen nt
  s_add_u32 s56, s56, 1280
  buffer_load_dword v20, v5, s[44:47], s56 offen nt
  s_add_u32 s56, s56, 1280
  buffer_load_dword v17, v5, s[44:47], s56 offen nt
  s_add_u32 s56, s56, 1280
  buffer_load_dword v21, v5, s[44:47], s56 offen nt
  s_add_u32 s56, s56, 1280
  buffer_load_dword v18, v5, s[44:47], s56 offen nt
  s_add_u32 s56, s56, 1280
  buffer_load_dword v22, v5, s[44:47], s56 offen nt
  s_add_u32 s56, s56, 1280
  buffer_load_dword v19, v5, s[44:47], s56 offen nt
  s_add_u32 s56, s56, 1280
  buffer_load_dword v23, v5, s[44:47], s56 offen nt
  s_add_u32 s56, s56, 32000
  s_add_u32 s56, s3, 20
  s_mul_i32 s56, s56, 81920
  buffer_load_dword v24, v5, s[44:47], s56 offen nt
  s_add_u32 s56, s56, 1280
  buffer_load_dword v28, v5, s[44:47], s56 offen nt
  s_add_u32 s56, s56, 1280
  buffer_load_dword v25, v5, s[44:47], s56 offen nt
  s_add_u32 s56, s56, 1280
  buffer_load_dword v29, v5, s[44:47], s56 offen nt
  s_add_u32 s56, s56, 1280
  buffer_load_dword v26, v5, s[44:47], s56 offen nt
  s_add_u32 s56, s56, 1280
  buffer_load_dword v30, v5, s[44:47], s56 offen nt
  s_add_u32 s56, s56, 1280
  buffer_load_dword v27, v5, s[44:47], s56 offen nt
  s_add_u32 s56, s56, 1280
  buffer_load_dword v31, v5, s[44:47], s56 offen nt
  s_add_u32 s56, s56, 32000
  buffer_load_dword v32, v5, s[44:47], s56 offen nt
  s_add_u32 s56, s56, 1280
  buffer_load_dword v36, v5, s[44:47], s56 offen nt
  s_add_u32 s56, s56, 1280
  buffer_load_dword v33, v5, s[44:47], s56 offen nt
  s_add_u32 s56, s56, 1280
  buffer_load_dword v37, v5, s[44:47], s56 offen nt
  s_add_u32 s56, s56, 1280
  buffer_load_dword v34, v5, s[44:47], s56 offen nt
  s_add_u32 s56, s56, 1280
  buffer_load_dword v38, v5, s[44:47], s56 offen nt
  s_add_u32 s56, s56, 1280
  buffer_load_dword v35, v5, s[44:47], s56 offen nt
  s_add_u32 s56, s56, 1280
  buffer_load_dword v39, v5, s[44:47], s56 offen nt
  s_add_u32 s56, s56, 32000
  s_waitcnt vmcnt(0)
  v_perm_b32 v104, v12, v8, s60
  v_perm_b32 v108, v12, v8, s61
  v_perm_b32 v105, v13, v9, s60
  v_perm_b32 v109, v13, v9, s61
  v_perm_b32 v106, v14, v10, s60
  v_perm_b32 v110, v14, v10, s61
  v_perm_b32 v107, v15, v11, s60
  v_perm_b32 v111, v15, v11, s61
  v_perm_b32 v112, v20, v16, s60
  v_perm_b32 v116, v20, v16, s61
  v_perm_b32 v113, v21, v17, s60
  v_perm_b32 v117, v21, v17, s61
  v_perm_b32 v114, v22, v18, s60
  v_perm_b32 v118, v22, v18, s61
  v_perm_b32 v115, v23, v19, s60
  v_perm_b32 v119, v23, v19, s61
  v_perm_b32 v120, v28, v24, s60
  v_perm_b32 v124, v28, v24, s61
  v_perm_b32 v121, v29, v25, s60
  v_perm_b32 v125, v29, v25, s61
  v_perm_b32 v122, v30, v26, s60
  v_perm_b32 v126, v30, v26, s61
  v_perm_b32 v123, v31, v27, s60
  v_perm_b32 v127, v31, v27, s61
  v_perm_b32 v128, v36, v32, s60
  v_perm_b32 v132, v36, v32, s61
  v_perm_b32 v129, v37, v33, s60
  v_perm_b32 v133, v37, v33, s61
  v_perm_b32 v130, v38, v34, s60
  v_perm_b32 v134, v38, v34, s61
  v_perm_b32 v131, v39, v35, s60
  v_perm_b32 v135, v39, v35, s61
  s_cmp_eq_u32 s3, 3
  s_cbranch_scc1 Lsk7_56
  s_add_u32 s56, s3, 24
  s_mul_i32 s56, s56, 81920
  buffer_load_dword v8, v5, s[44:47], s56 offen nt
  s_add_u32 s56, s56, 1280
  buffer_load_dword v12, v5, s[44:47], s56 offen nt
  s_add_u32 s56, s56, 1280
  buffer_load_dword v9, v5, s[44:47], s56 offen nt
  s_add_u32 s56, s56, 1280
  buffer_load_dword v13, v5, s[44:47], s56 offen nt
  s_add_u32 s56, s56, 1280
  buffer_load_dword v10, v5, s[44:47], s56 offen nt
  s_add_u32 s56, s56, 1280
  buffer_load_dword v14, v5, s[44:47], s56 offen nt
  s_add_u32 s56, s56, 1280
  buffer_load_dword v11, v5, s[44:47], s56 offen nt
  s_add_u32 s56, s56, 1280
  buffer_load_dword v15, v5, s[44:47], s56 offen nt
  s_add_u32 s56, s56, 32000
  buffer_load_dword v16, v5, s[44:47], s56 offen nt
  s_add_u32 s56, s56, 1280
  buffer_load_dword v20, v5, s[44:47], s56 offen nt
  s_add_u32 s56, s56, 1280
  buffer_load_dword v17, v5, s[44:47], s56 offen nt
  s_add_u32 s56, s56, 1280
  buffer_load_dword v21, v5, s[44:47], s56 offen nt
  s_add_u32 s56, s56, 1280
  buffer_load_dword v18, v5, s[44:47], s56 offen nt
  s_add_u32 s56, s56, 1280
  buffer_load_dword v22, v5, s[44:47], s56 offen nt
  s_add_u32 s56, s56, 1280
  buffer_load_dword v19, v5, s[44:47], s56 offen nt
  s_add_u32 s56, s56, 1280
  buffer_load_dword v23, v5, s[44:47], s56 offen nt
  s_add_u32 s56, s56, 32000
Lsk7_56:
  s_waitcnt vmcnt(0)
  s_cmp_eq_u32 s3, 3
  s_cbranch_scc1 Lsk7_57
  v_perm_b32 v136, v12, v8, s60
  v_perm_b32 v140, v12, v8, s61
  v_perm_b32 v137, v13, v9, s60
  v_perm_b32 v141, v13, v9, s61
  v_perm_b32 v138, v14, v10, s60
  v_perm_b32 v142, v14, v10, s61
  v_perm_b32 v139, v15, v11, s60
  v_perm_b32 v143, v15, v11, s61
  v_perm_b32 v144, v20, v16, s60
  v_perm_b32 v148, v20, v16, s61
  v_perm_b32 v145, v21, v17, s60
  v_perm_b32 v149, v21, v17, s61
  v_perm_b32 v146, v22, v18, s60
  v_perm_b32 v150, v22, v18, s61
  v_perm_b32 v147, v23, v19, s60
  v_perm_b32 v151, v23, v19, s61
Lsk7_57:
  s_cmp_lg_u32 s3, 0
  s_cbranch_scc1 Lnordy_58
  v_lshlrev_b32 v12, 4, v0
  s_mov_b32 s56, 520192
Lpoll_59:
  buffer_load_dwordx4 v[8:11], v12, s[36:39], s56 offen sc1
  s_waitcnt vmcnt(0)
  v_cmp_ne_u32 vcc, s31, v8
  v_cmp_ne_u32 s[58:59], s31, v9
  s_or_b64 vcc, vcc, s[58:59]
  v_cmp_ne_u32 s[58:59], s31, v10
  s_or_b64 vcc, vcc, s[58:59]
  v_cmp_ne_u32 s[58:59], s31, v11
  s_or_b64 vcc, vcc, s[58:59]
  s_cbranch_vccz Lpd_60
  s_sleep 100
  s_add_u32 s30, s30, 1
  s_cmp_gt_u32 s30, 400000
  s_cbranch_scc0 Lpoll_59
Lpd_60:
Lnordy_58:
  s_cmp_lg_u32 s3, 3
  s_cbranch_scc1 L_WDONE
  s_mov_b32 s48, s8
  s_mov_b32 s49, s9
  s_mov_b32 s50, 10240
  s_mov_b32 s51, 0x20000
  v_lshrrev_b32 v6, 3, v0
  v_and_b32 v7, 7, v0
  v_lshlrev_b32 v7, 3, v7
  s_movk_i32 s57, 1280
  v_mul_lo_u32 v8, v6, s57
  v_add_u32 v8, v8, v7
  s_sub_u32 s57, s2, 211
  s_lshl_b32 s56, s57, 6
  buffer_load_dwordx2 v[144:145], v8, s[48:51], s56 offen
  v_lshlrev_b32 v9, 8, v6
  v_lshl_add_u32 v9, v7, 1, v9
  s_lshr_b32 s56, s57, 1
  s_lshl_b32 s56, s56, 11
  s_and_b32 s57, s57, 1
  s_lshl_b32 s57, s57, 7
  s_add_u32 s56, s56, s57
  s_add_u32 s57, s56, 40960
  s_add_u32 s56, s56, 102400
Lpoll_61:
  buffer_load_dwordx4 v[136:139], v9, s[36:39], s57 offen sc1
  buffer_load_dwordx4 v[140:143], v9, s[36:39], s56 offen sc1
  s_waitcnt vmcnt(0)
  v_cmp_ne_u32 vcc, s31, v137
  v_cmp_ne_u32 s[58:59], s31, v141
  s_or_b64 vcc, vcc, s[58:59]
  s_cbranch_vccz Lpd_62
  s_sleep 100
  s_add_u32 s30, s30, 1
  s_cmp_gt_u32 s30, 400000
  s_cbranch_scc0 Lpoll_61
Lpd_62:
  v_mov_b32 v146, v136
  v_mov_b32 v147, v138
  v_mov_b32 v148, v140
  v_mov_b32 v149, v142
L_WDONE:
  s_barrier
  s_cmp_lg_u32 s3, 0
  s_cbranch_scc1 Lmd_63
  v_lshlrev_b32 v6, 3, v0
  v_mov_b32 v7, 0
  ds_read_b64 v[8:9], v6 offset:16704
  ds_read_b64 v[10:11], v6 offset:17216
  ds_read_b64 v[12:13], v6 offset:17728
  ds_read_b64 v[14:15], v6 offset:18240
  ds_read_b64 v[16:17], v6 offset:18752
  ds_read_b64 v[18:19], v6 offset:19264
  ds_read_b64 v[20:21], v6 offset:19776
  ds_read_b64 v[22:23], v6 offset:20288
  ds_read_b128 v[24:27], v7 offset:20800
  ds_read_b128 v[28:31], v7 offset:20816
  ds_read_b128 v[32:35], v7 offset:20832
  ds_read_b128 v[36:39], v7 offset:20848
  s_waitcnt lgkmcnt(0)
  v_max3_f32 v6, v24, v26, v28
  v_max3_f32 v6, v6, v30, v32
  v_max3_f32 v6, v6, v34, v36
  v_max_f32 v6, v6, v38
  s_mov_b32 s57, 0x3e0293ee
  v_sub_f32 v24, v24, v6
  v_sub_f32 v26, v26, v6
  v_sub_f32 v28, v28, v6
  v_sub_f32 v30, v30, v6
  v_sub_f32 v32, v32, v6
  v_sub_f32 v34, v34, v6
  v_sub_f32 v36, v36, v6
  v_sub_f32 v38, v38, v6
  v_mul_f32 v24, s57, v24
  v_mul_f32 v26, s57, v26
  v_mul_f32 v28, s57, v28
  v_mul_f32 v30, s57, v30
  v_mul_f32 v32, s57, v32
  v_mul_f32 v34, s57, v34
  v_mul_f32 v36, s57, v36
  v_mul_f32 v38, s57, v38
  v_exp_f32 v24, v24
  v_exp_f32 v26, v26
  v_exp_f32 v28, v28
  v_exp_f32 v30, v30
  v_exp_f32 v32, v32
  v_exp_f32 v34, v34
  v_exp_f32 v36, v36
  v_exp_f32 v38, v38
  s_nop 0
  v_mul_f32 v7, v24, v25
  v_mul_f32 v156, v8, v24
  v_mul_f32 v157, v9, v24
  v_fmac_f32 v7, v26, v27
  v_fmac_f32 v156, v10, v26
  v_fmac_f32 v157, v11, v26
  v_fmac_f32 v7, v28, v29
  v_fmac_f32 v156, v12, v28
  v_fmac_f32 v157, v13, v28
  v_fmac_f32 v7, v30, v31
  v_fmac_f32 v156, v14, v30
  v_fmac_f32 v157, v15, v30
  v_fmac_f32 v7, v32, v33
  v_fmac_f32 v156, v16, v32
  v_fmac_f32 v157, v17, v32
  v_fmac_f32 v7, v34, v35
  v_fmac_f32 v156, v18, v34
  v_fmac_f32 v157, v19, v34
  v_fmac_f32 v7, v36, v37
  v_fmac_f32 v156, v20, v36
  v_fmac_f32 v157, v21, v36
  v_fmac_f32 v7, v38, v39
  v_fmac_f32 v156, v22, v38
  v_fmac_f32 v157, v23, v38
  v_rcp_f32 v7, v7
  s_nop 0
  v_mul_f32 v156, v156, v7
  v_mul_f32 v157, v157, v7
  v_cvt_pk_bf16_f32 v156, v156, v157
  v_min_u32 v156, 0xfffeffff, v156
  s_lshl_b32 s56, s35, 3
  s_add_u32 s56, s56, s34
  s_lshl_b32 s56, s56, 8
  s_add_u32 s56, s56, 262144
  v_lshlrev_b32 v6, 2, v0
  buffer_store_dword v156, v6, s[36:39], s56 offen sc1
Lmd_63:
  s_cmp_ge_u32 s2, 231
  s_cbranch_scc1 L_END
  s_cmp_ge_u32 s2, 211
  s_cbranch_scc1 L_E3
  s_cmp_ge_u32 s2, 184
  s_cbranch_scc1 L_E2
  s_cmp_lt_u32 s2, 104
  s_cbranch_scc1 L_END
  v_lshrrev_b32 v7, 3, v2
  v_lshlrev_b32 v7, 6, v7
  v_lshl_add_u32 v7, v1, 4, v7
  v_lshl_add_u32 v6, v3, 8, v7
  s_lshl_b32 s56, s66, 2
  s_add_u32 s56, s56, s3
  s_lshl_b32 s56, s56, 11
  s_add_u32 s56, s56, 262144
Lpoll_64:
  buffer_load_dwordx4 v[8:11], v6, s[36:39], s56 offen offset:0 sc1
  buffer_load_dwordx4 v[12:15], v6, s[36:39], s56 offen offset:128 sc1
  s_waitcnt vmcnt(0)
  v_cmp_eq_u32 vcc, -1, v8
  v_cmp_eq_u32 s[58:59], -1, v9
  s_or_b64 vcc, vcc, s[58:59]
  v_cmp_eq_u32 s[58:59], -1, v10
  s_or_b64 vcc, vcc, s[58:59]
  v_cmp_eq_u32 s[58:59], -1, v11
  s_or_b64 vcc, vcc, s[58:59]
  v_cmp_eq_u32 s[58:59], -1, v12
  s_or_b64 vcc, vcc, s[58:59]
  v_cmp_eq_u32 s[58:59], -1, v13
  s_or_b64 vcc, vcc, s[58:59]
  v_cmp_eq_u32 s[58:59], -1, v14
  s_or_b64 vcc, vcc, s[58:59]
  v_cmp_eq_u32 s[58:59], -1, v15
  s_or_b64 vcc, vcc, s[58:59]
  s_cbranch_vccz Lpd_65
  s_add_u32 s30, s30, 1
  s_cmp_gt_u32 s30, 400000
  s_cbranch_scc0 Lpoll_64
Lpd_65:
  v_mfma_f32_16x16x32_bf16 v[104:107], v[8:11], v[40:43], 0
  v_mfma_f32_16x16x32_bf16 v[108:111], v[8:11], v[44:47], 0
  v_mfma_f32_16x16x32_bf16 v[112:115], v[8:11], v[48:51], 0
  v_mfma_f32_16x16x32_bf16 v[116:119], v[8:11], v[52:55], 0
  v_mfma_f32_16x16x32_bf16 v[120:123], v[8:11], v[56:59], 0
  v_mfma_f32_16x16x32_bf16 v[124:127], v[8:11], v[60:63], 0
  v_mfma_f32_16x16x32_bf16 v[128:131], v[8:11], v[64:67], 0
  v_mfma_f32_16x16x32_bf16 v[132:135], v[8:11], v[68:71], 0
  v_mfma_f32_16x16x32_bf16 v[104:107], v[12:15], v[72:75], v[104:107]
  v_mfma_f32_16x16x32_bf16 v[108:111], v[12:15], v[76:79], v[108:111]
  v_mfma_f32_16x16x32_bf16 v[112:115], v[12:15], v[80:83], v[112:115]
  v_mfma_f32_16x16x32_bf16 v[116:119], v[12:15], v[84:87], v[116:119]
  v_mfma_f32_16x16x32_bf16 v[120:123], v[12:15], v[88:91], v[120:123]
  v_mfma_f32_16x16x32_bf16 v[124:127], v[12:15], v[92:95], v[124:127]
  v_mfma_f32_16x16x32_bf16 v[128:131], v[12:15], v[96:99], v[128:131]
  v_mfma_f32_16x16x32_bf16 v[132:135], v[12:15], v[100:103], v[132:135]
  v_lshrrev_b32 v6, 1, v1
  v_lshlrev_b32 v6, 11, v6
  v_and_b32 v7, 1, v1
  v_lshl_add_u32 v6, v7, 10, v6
  v_lshl_add_u32 v6, v2, 4, v6
  s_lshl_b32 s56, s3, 12
  v_add_u32 v6, s56, v6
  s_mov_b32 s58, 0
  s_mov_b32 s59, -1
  s_nop 2
  v_cndmask_b32 v136, v104, v120, s[58:59]
  v_cndmask_b32 v137, v108, v124, s[58:59]
  v_cndmask_b32 v138, v112, v128, s[58:59]
  v_cndmask_b32 v139, v116, v132, s[58:59]
  v_cndmask_b32 v140, v105, v121, s[58:59]
  v_cndmask_b32 v141, v109, v125, s[58:59]
  v_cndmask_b32 v142, v113, v129, s[58:59]
  v_cndmask_b32 v143, v117, v133, s[58:59]
  v_cndmask_b32 v144, v106, v122, s[58:59]
  v_cndmask_b32 v145, v110, v126, s[58:59]
  v_cndmask_b32 v146, v114, v130, s[58:59]
  v_cndmask_b32 v147, v118, v134, s[58:59]
  v_cndmask_b32 v148, v107, v123, s[58:59]
  v_cndmask_b32 v149, v111, v127, s[58:59]
  v_cndmask_b32 v150, v115, v131, s[58:59]
  v_cndmask_b32 v151, v119, v135, s[58:59]
  ds_write_b128 v6, v[136:139] offset:0
  ds_write_b128 v6, v[140:143] offset:256
  ds_write_b128 v6, v[144:147] offset:512
  ds_write_b128 v6, v[148:151] offset:768
  s_waitcnt lgkmcnt(0)
  s_barrier
  s_cmp_ge_u32 s3, 2
  s_cbranch_scc1 L_END
  v_lshrrev_b32 v6, 3, v0
  v_lshlrev_b32 v6, 8, v6
  v_and_b32 v7, 7, v0
  v_lshl_add_u32 v6, v7, 4, v6
  s_lshl_b32 s56, s3, 7
  v_add_u32 v6, s56, v6
  ds_read_b128 v[20:23], v6 offset:0
  ds_read_b128 v[24:27], v6 offset:2048
  ds_read_b128 v[28:31], v6 offset:4096
  ds_read_b128 v[32:35], v6 offset:6144
  ds_read_b128 v[36:39], v6 offset:8192
  ds_read_b128 v[40:43], v6 offset:10240
  ds_read_b128 v[44:47], v6 offset:12288
  ds_read_b128 v[48:51], v6 offset:14336
  s_waitcnt lgkmcnt(0)
  v_add_f32 v20, v20, v24
  v_add_f32 v21, v21, v25
  v_add_f32 v22, v22, v26
  v_add_f32 v23, v23, v27
  v_add_f32 v28, v28, v32
  v_add_f32 v29, v29, v33
  v_add_f32 v30, v30, v34
  v_add_f32 v31, v31, v35
  v_add_f32 v36, v36, v40
  v_add_f32 v37, v37, v41
  v_add_f32 v38, v38, v42
  v_add_f32 v39, v39, v43
  v_add_f32 v44, v44, v48
  v_add_f32 v45, v45, v49
  v_add_f32 v46, v46, v50
  v_add_f32 v47, v47, v51
  v_add_f32 v20, v20, v28
  v_add_f32 v21, v21, v29
  v_add_f32 v22, v22, v30
  v_add_f32 v23, v23, v31
  v_add_f32 v36, v36, v44
  v_add_f32 v37, v37, v45
  v_add_f32 v38, v38, v46
  v_add_f32 v39, v39, v47
  v_add_f32 v8, v20, v36
  v_add_f32 v9, v21, v37
  v_add_f32 v10, v22, v38
  v_add_f32 v11, v23, v39
  v_min_u32 v8, 0xfffeffff, v8
  v_min_u32 v9, 0xfffeffff, v9
  v_min_u32 v10, 0xfffeffff, v10
  v_min_u32 v11, 0xfffeffff, v11
  s_lshl_b32 s56, s69, 11
  s_add_u32 s56, s56, 327680
  buffer_store_dwordx4 v[8:11], v6, s[36:39], s56 offen sc1
  s_branch L_END
L_E2:
  s_cmp_ge_u32 s68, 10
  s_cbranch_scc1 Le2idle_66
  s_lshl_b32 s56, s68, 10
  s_add_u32 s56, s56, 524288
Lpoll_68:
  buffer_load_dwordx4 v[16:19], v4, s[36:39], s56 offen sc1
  s_waitcnt vmcnt(0)
  v_cmp_eq_u32 vcc, -1, v16
  v_cmp_eq_u32 s[58:59], -1, v17
  s_or_b64 vcc, vcc, s[58:59]
  v_cmp_eq_u32 s[58:59], -1, v18
  s_or_b64 vcc, vcc, s[58:59]
  v_cmp_eq_u32 s[58:59], -1, v19
  s_or_b64 vcc, vcc, s[58:59]
  s_cbranch_vccz Lpd_69
  s_add_u32 s30, s30, 1
  s_cmp_gt_u32 s30, 400000
  s_cbranch_scc0 Lpoll_68
Lpd_69:
  v_lshlrev_b32 v8, 16, v16
  v_and_b32 v9, 0xffff0000, v16
  v_lshlrev_b32 v10, 16, v17
  v_and_b32 v11, 0xffff0000, v17
  v_lshlrev_b32 v12, 16, v18
  v_and_b32 v13, 0xffff0000, v18
  v_lshlrev_b32 v14, 16, v19
  v_and_b32 v15, 0xffff0000, v19
  v_add_f32 v32, v8, v9
  v_mul_f32 v33, v8, v8
  v_fmac_f32 v33, v9, v9
  v_add_f32 v32, v32, v10
  v_fmac_f32 v33, v10, v10
  v_add_f32 v32, v32, v11
  v_fmac_f32 v33, v11, v11
  v_add_f32 v32, v32, v12
  v_fmac_f32 v33, v12, v12
  v_add_f32 v32, v32, v13
  v_fmac_f32 v33, v13, v13
  v_add_f32 v32, v32, v14
  v_fmac_f32 v33, v14, v14
  v_add_f32 v32, v32, v15
  v_fmac_f32 v33, v15, v15
  s_nop 1
  v_add_f32_dpp v32, v32, v32 row_ror:8 row_mask:0xf bank_mask:0xf
  v_mov_b32 v34, v32
  s_nop 1
  v_permlane16_swap_b32 v32, v34
  s_nop 1
  v_add_f32 v32, v32, v34
  v_mov_b32 v34, v32
  s_nop 1
  v_permlane32_swap_b32 v32, v34
  s_nop 1
  v_add_f32 v32, v32, v34
  s_nop 1
  v_add_f32_dpp v33, v33, v33 row_ror:8 row_mask:0xf bank_mask:0xf
  v_mov_b32 v34, v33
  s_nop 1
  v_permlane16_swap_b32 v33, v34
  s_nop 1
  v_add_f32 v33, v33, v34
  v_mov_b32 v34, v33
  s_nop 1
  v_permlane32_swap_b32 v33, v34
  s_nop 1
  v_add_f32 v33, v33, v34
  v_lshlrev_b32 v7, 3, v3
  s_lshl_b32 s56, s68, 6
  v_add_u32 v7, s56, v7
  ds_write_b64 v7, v[32:33] offset:20864
  s_waitcnt lgkmcnt(0)
Le2idle_66:
  s_barrier
  s_cmp_ge_u32 s68, 10
  s_cbranch_scc1 Le2idle_67
  v_lshlrev_b32 v7, 3, v3
  ds_read_b64 v[116:117], v7 offset:20864
  ds_read_b64 v[118:119], v7 offset:20928
  ds_read_b64 v[120:121], v7 offset:20992
  ds_read_b64 v[122:123], v7 offset:21056
  ds_read_b64 v[124:125], v7 offset:21120
  ds_read_b64 v[126:127], v7 offset:21184
  ds_read_b64 v[128:129], v7 offset:21248
  ds_read_b64 v[130:131], v7 offset:21312
  ds_read_b64 v[132:133], v7 offset:21376
  ds_read_b64 v[134:135], v7 offset:21440
  s_waitcnt lgkmcnt(0)
  v_add_f32 v116, v116, v118
  v_add_f32 v117, v117, v119
  v_add_f32 v120, v120, v122
  v_add_f32 v121, v121, v123
  v_add_f32 v124, v124, v126
  v_add_f32 v125, v125, v127
  v_add_f32 v128, v128, v130
  v_add_f32 v129, v129, v131
  v_add_f32 v132, v132, v134
  v_add_f32 v133, v133, v135
  v_add_f32 v116, v116, v120
  v_add_f32 v117, v117, v121
  v_add_f32 v124, v124, v128
  v_add_f32 v125, v125, v129
  v_add_f32 v116, v116, v124
  v_add_f32 v117, v117, v125
  v_add_f32 v32, v116, v132
  v_add_f32 v33, v117, v133
  v_mul_f32 v32, 0x3acccccd, v32
  v_mul_f32 v33, 0x3acccccd, v33
  v_fma_f32 v33, -v32, v32, v33
  v_max_f32 v33, 0, v33
  v_cvt_pk_bf16_f32 v34, v32, v33
  v_lshlrev_b32 v36, 16, v34
  v_and_b32 v33, 0xffff0000, v34
  v_add_f32 v33, 0x3727c5ac, v33
  v_cvt_pk_bf16_f32 v34, v33, v33
  v_lshlrev_b32 v33, 16, v34
  v_sqrt_f32 v33, v33
  s_nop 0
  v_cvt_pk_bf16_f32 v34, v33, v33
  v_lshlrev_b32 v33, 16, v34
  v_rcp_f32 v37, v33
  s_nop 0
  v_sub_f32 v8, v8, v36
  v_sub_f32 v9, v9, v36
  v_cvt_pk_bf16_f32 v34, v8, v9
  v_lshlrev_b32 v8, 16, v34
  v_and_b32 v9, 0xffff0000, v34
  v_mul_f32 v8, v8, v37
  v_mul_f32 v9, v9, v37
  v_cvt_pk_bf16_f32 v34, v8, v9
  v_lshlrev_b32 v8, 16, v34
  v_and_b32 v9, 0xffff0000, v34
  v_mul_f32 v8, v8, v108
  v_mul_f32 v9, v9, v109
  v_cvt_pk_bf16_f32 v34, v8, v9
  v_lshlrev_b32 v8, 16, v34
  v_and_b32 v9, 0xffff0000, v34
  v_add_f32 v8, v8, v100
  v_add_f32 v9, v9, v101
  v_cvt_pk_bf16_f32 v16, v8, v9
  v_sub_f32 v10, v10, v36
  v_sub_f32 v11, v11, v36
  v_cvt_pk_bf16_f32 v34, v10, v11
  v_lshlrev_b32 v10, 16, v34
  v_and_b32 v11, 0xffff0000, v34
  v_mul_f32 v10, v10, v37
  v_mul_f32 v11, v11, v37
  v_cvt_pk_bf16_f32 v34, v10, v11
  v_lshlrev_b32 v10, 16, v34
  v_and_b32 v11, 0xffff0000, v34
  v_mul_f32 v10, v10, v110
  v_mul_f32 v11, v11, v111
  v_cvt_pk_bf16_f32 v34, v10, v11
  v_lshlrev_b32 v10, 16, v34
  v_and_b32 v11, 0xffff0000, v34
  v_add_f32 v10, v10, v102
  v_add_f32 v11, v11, v103
  v_cvt_pk_bf16_f32 v17, v10, v11
  v_sub_f32 v12, v12, v36
  v_sub_f32 v13, v13, v36
  v_cvt_pk_bf16_f32 v34, v12, v13
  v_lshlrev_b32 v12, 16, v34
  v_and_b32 v13, 0xffff0000, v34
  v_mul_f32 v12, v12, v37
  v_mul_f32 v13, v13, v37
  v_cvt_pk_bf16_f32 v34, v12, v13
  v_lshlrev_b32 v12, 16, v34
  v_and_b32 v13, 0xffff0000, v34
  v_mul_f32 v12, v12, v112
  v_mul_f32 v13, v13, v113
  v_cvt_pk_bf16_f32 v34, v12, v13
  v_lshlrev_b32 v12, 16, v34
  v_and_b32 v13, 0xffff0000, v34
  v_add_f32 v12, v12, v104
  v_add_f32 v13, v13, v105
  v_cvt_pk_bf16_f32 v18, v12, v13
  v_sub_f32 v14, v14, v36
  v_sub_f32 v15, v15, v36
  v_cvt_pk_bf16_f32 v34, v14, v15
  v_lshlrev_b32 v14, 16, v34
  v_and_b32 v15, 0xffff0000, v34
  v_mul_f32 v14, v14, v37
  v_mul_f32 v15, v15, v37
  v_cvt_pk_bf16_f32 v34, v14, v15
  v_lshlrev_b32 v14, 16, v34
  v_and_b32 v15, 0xffff0000, v34
  v_mul_f32 v14, v14, v114
  v_mul_f32 v15, v15, v115
  v_cvt_pk_bf16_f32 v34, v14, v15
  v_lshlrev_b32 v14, 16, v34
  v_and_b32 v15, 0xffff0000, v34
  v_add_f32 v14, v14, v106
  v_add_f32 v15, v15, v107
  v_cvt_pk_bf16_f32 v19, v14, v15
  s_nop 1
  v_mfma_f32_16x16x32_bf16 v[116:119], v[16:19], v[40:43], 0
  v_mfma_f32_16x16x32_bf16 v[120:123], v[16:19], v[44:47], 0
  v_mfma_f32_16x16x32_bf16 v[124:127], v[16:19], v[48:51], 0
  v_mfma_f32_16x16x32_bf16 v[128:131], v[16:19], v[52:55], 0
  v_mfma_f32_16x16x32_bf16 v[132:135], v[16:19], v[56:59], 0
  v_mfma_f32_16x16x32_bf16 v[136:139], v[16:19], v[60:63], 0
  v_mfma_f32_16x16x32_bf16 v[140:143], v[16:19], v[64:67], 0
  v_mfma_f32_16x16x32_bf16 v[144:147], v[16:19], v[68:71], 0
  v_lshrrev_b32 v6, 1, v1
  v_lshlrev_b32 v6, 11, v6
  v_and_b32 v7, 1, v1
  v_lshl_add_u32 v6, v7, 10, v6
  v_lshl_add_u32 v6, v2, 4, v6
  s_lshl_b32 s56, s68, 12
  v_add_u32 v6, s56, v6
  s_mov_b32 s58, 0
  s_mov_b32 s59, -1
  s_nop 2
  v_cndmask_b32 v8, v116, v132, s[58:59]
  v_cndmask_b32 v9, v120, v136, s[58:59]
  v_cndmask_b32 v10, v124, v140, s[58:59]
  v_cndmask_b32 v11, v128, v144, s[58:59]
  v_cndmask_b32 v12, v117, v133, s[58:59]
  v_cndmask_b32 v13, v121, v137, s[58:59]
  v_cndmask_b32 v14, v125, v141, s[58:59]
  v_cndmask_b32 v15, v129, v145, s[58:59]
  v_cndmask_b32 v16, v118, v134, s[58:59]
  v_cndmask_b32 v17, v122, v138, s[58:59]
  v_cndmask_b32 v18, v126, v142, s[58:59]
  v_cndmask_b32 v19, v130, v146, s[58:59]
  v_cndmask_b32 v20, v119, v135, s[58:59]
  v_cndmask_b32 v21, v123, v139, s[58:59]
  v_cndmask_b32 v22, v127, v143, s[58:59]
  v_cndmask_b32 v23, v131, v147, s[58:59]
  ds_write_b128 v6, v[8:11] offset:24576
  ds_write_b128 v6, v[12:15] offset:24832
  ds_write_b128 v6, v[16:19] offset:25088
  ds_write_b128 v6, v[20:23] offset:25344
  s_waitcnt lgkmcnt(0)
Le2idle_67:
  s_barrier
  s_cmp_ge_u32 s68, 4
  s_cbranch_scc1 L_END
  v_lshlrev_b32 v6, 3, v0
  s_lshl_b32 s56, s68, 9
  v_add_u32 v6, s56, v6
  ds_read_b64 v[40:41], v6 offset:24576
  ds_read_b64 v[42:43], v6 offset:26624
  ds_read_b64 v[44:45], v6 offset:28672
  ds_read_b64 v[46:47], v6 offset:30720
  ds_read_b64 v[48:49], v6 offset:32768
  ds_read_b64 v[50:51], v6 offset:34816
  ds_read_b64 v[52:53], v6 offset:36864
  ds_read_b64 v[54:55], v6 offset:38912
  ds_read_b64 v[56:57], v6 offset:40960
  ds_read_b64 v[58:59], v6 offset:43008
  ds_read_b64 v[60:61], v6 offset:45056
  ds_read_b64 v[62:63], v6 offset:47104
  ds_read_b64 v[64:65], v6 offset:49152
  ds_read_b64 v[66:67], v6 offset:51200
  ds_read_b64 v[68:69], v6 offset:53248
  ds_read_b64 v[70:71], v6 offset:55296
  ds_read_b64 v[72:73], v6 offset:57344
  ds_read_b64 v[74:75], v6 offset:59392
  ds_read_b64 v[76:77], v6 offset:61440
  ds_read_b64 v[78:79], v6 offset:63488
  s_waitcnt lgkmcnt(0)
  v_add_f32 v40, v40, v42
  v_add_f32 v41, v41, v43
  v_add_f32 v44, v44, v46
  v_add_f32 v45, v45, v47
  v_add_f32 v48, v48, v50
  v_add_f32 v49, v49, v51
  v_add_f32 v52, v52, v54
  v_add_f32 v53, v53, v55
  v_add_f32 v56, v56, v58
  v_add_f32 v57, v57, v59
  v_add_f32 v60, v60, v62
  v_add_f32 v61, v61, v63
  v_add_f32 v64, v64, v66
  v_add_f32 v65, v65, v67
  v_add_f32 v68, v68, v70
  v_add_f32 v69, v69, v71
  v_add_f32 v72, v72, v74
  v_add_f32 v73, v73, v75
  v_add_f32 v76, v76, v78
  v_add_f32 v77, v77, v79
  v_add_f32 v40, v40, v44
  v_add_f32 v41, v41, v45
  v_add_f32 v48, v48, v52
  v_add_f32 v49, v49, v53
  v_add_f32 v56, v56, v60
  v_add_f32 v57, v57, v61
  v_add_f32 v64, v64, v68
  v_add_f32 v65, v65, v69
  v_add_f32 v72, v72, v76
  v_add_f32 v73, v73, v77
  v_add_f32 v40, v40, v48
  v_add_f32 v41, v41, v49
  v_add_f32 v56, v56, v64
  v_add_f32 v57, v57, v65
  v_add_f32 v40, v40, v56
  v_add_f32 v41, v41, v57
  v_add_f32 v40, v40, v72
  v_add_f32 v41, v41, v73
  v_cvt_pk_bf16_f32 v12, v40, v41
  v_lshlrev_b32 v40, 16, v12
  v_and_b32 v41, 0xffff0000, v12
  v_mul_f32 v12, 0xbfb8aa3b, v40
  v_mul_f32 v13, 0xbfb8aa3b, v41
  v_exp_f32 v12, v12
  v_exp_f32 v13, v13
  s_nop 0
  v_add_f32 v12, 1.0, v12
  v_add_f32 v13, 1.0, v13
  v_rcp_f32 v12, v12
  v_rcp_f32 v13, v13
  s_nop 0
  v_mul_f32 v40, v40, v12
  v_mul_f32 v41, v41, v13
  v_cvt_pk_bf16_f32 v8, v40, v41
  v_min_u32 v8, 0xfffeffff, v8
  v_lshlrev_b32 v6, 2, v0
  s_sub_u32 s56, s2, 184
  s_lshl_b32 s56, s56, 10
  s_lshl_b32 s57, s68, 8
  s_add_u32 s56, s56, s57
  s_add_u32 s56, s56, 491520
  buffer_store_dword v8, v6, s[36:39], s56 offen sc1
  s_branch L_END
L_E3:
  s_cmp_lg_u32 s3, 3
  s_cbranch_scc1 Lfin_70
  v_lshrrev_b32 v6, 3, v0
  v_lshlrev_b32 v6, 8, v6
  v_and_b32 v7, 7, v0
  v_lshl_add_u32 v6, v7, 4, v6
  s_sub_u32 s57, s2, 211
  s_lshr_b32 s56, s57, 1
  s_lshl_b32 s56, s56, 11
  s_and_b32 s57, s57, 1
  s_lshl_b32 s57, s57, 7
  s_add_u32 s56, s56, s57
  s_add_u32 s56, s56, 327680
  s_add_u32 s62, s56, 20480
  s_add_u32 s63, s56, 40960
  s_add_u32 s64, s56, 61440
  s_add_u32 s65, s56, 81920
  s_add_u32 s66, s56, 102400
  s_add_u32 s67, s56, 122880
  s_add_u32 s68, s56, 143360
Lpoll_71:
  buffer_load_dwordx4 v[8:11], v6, s[36:39], s56 offen sc1
  buffer_load_dwordx4 v[12:15], v6, s[36:39], s62 offen sc1
  buffer_load_dwordx4 v[16:19], v6, s[36:39], s63 offen sc1
  buffer_load_dwordx4 v[20:23], v6, s[36:39], s64 offen sc1
  buffer_load_dwordx4 v[24:27], v6, s[36:39], s65 offen sc1
  buffer_load_dwordx4 v[28:31], v6, s[36:39], s66 offen sc1
  buffer_load_dwordx4 v[32:35], v6, s[36:39], s67 offen sc1
  buffer_load_dwordx4 v[36:39], v6, s[36:39], s68 offen sc1
  s_waitcnt vmcnt(0)
  v_cmp_eq_u32 vcc, -1, v8
  v_cmp_eq_u32 s[58:59], -1, v12
  s_or_b64 vcc, vcc, s[58:59]
  v_cmp_eq_u32 s[58:59], -1, v16
  s_or_b64 vcc, vcc, s[58:59]
  v_cmp_eq_u32 s[58:59], -1, v20
  s_or_b64 vcc, vcc, s[58:59]
  v_cmp_eq_u32 s[58:59], -1, v24
  s_or_b64 vcc, vcc, s[58:59]
  v_cmp_eq_u32 s[58:59], -1, v28
  s_or_b64 vcc, vcc, s[58:59]
  v_cmp_eq_u32 s[58:59], -1, v32
  s_or_b64 vcc, vcc, s[58:59]
  v_cmp_eq_u32 s[58:59], -1, v36
  s_or_b64 vcc, vcc, s[58:59]
  s_cbranch_vccz Lpd_72
  s_add_u32 s30, s30, 1
  s_cmp_gt_u32 s30, 400000
  s_cbranch_scc0 Lpoll_71
Lpd_72:
  v_add_f32 v8, v8, v12
  v_add_f32 v16, v16, v20
  v_add_f32 v24, v24, v28
  v_add_f32 v32, v32, v36
  v_add_f32 v8, v8, v16
  v_add_f32 v24, v24, v32
  v_add_f32 v136, v8, v24
  v_add_f32 v9, v9, v13
  v_add_f32 v17, v17, v21
  v_add_f32 v25, v25, v29
  v_add_f32 v33, v33, v37
  v_add_f32 v9, v9, v17
  v_add_f32 v25, v25, v33
  v_add_f32 v137, v9, v25
  v_add_f32 v10, v10, v14
  v_add_f32 v18, v18, v22
  v_add_f32 v26, v26, v30
  v_add_f32 v34, v34, v38
  v_add_f32 v10, v10, v18
  v_add_f32 v26, v26, v34
  v_add_f32 v138, v10, v26
  v_add_f32 v11, v11, v15
  v_add_f32 v19, v19, v23
  v_add_f32 v27, v27, v31
  v_add_f32 v35, v35, v39
  v_add_f32 v11, v11, v19
  v_add_f32 v27, v27, v35
  v_add_f32 v139, v11, v27
  v_cvt_pk_bf16_f32 v24, v136, v137
  v_lshlrev_b32 v136, 16, v24
  v_and_b32 v137, 0xffff0000, v24
  v_lshlrev_b32 v25, 16, v146
  v_and_b32 v26, 0xffff0000, v146
  v_mul_f32 v136, v136, v25
  v_mul_f32 v137, v137, v26
  v_cvt_pk_bf16_f32 v24, v136, v137
  v_lshlrev_b32 v136, 16, v24
  v_and_b32 v137, 0xffff0000, v24
  v_lshlrev_b32 v25, 16, v144
  v_and_b32 v26, 0xffff0000, v144
  v_add_f32 v136, v136, v25
  v_add_f32 v137, v137, v26
  v_cvt_pk_bf16_f32 v28, v136, v137
  v_lshlrev_b32 v136, 16, v28
  v_and_b32 v137, 0xffff0000, v28
  v_cvt_pk_bf16_f32 v24, v138, v139
  v_lshlrev_b32 v138, 16, v24
  v_and_b32 v139, 0xffff0000, v24
  v_lshlrev_b32 v25, 16, v147
  v_and_b32 v26, 0xffff0000, v147
  v_mul_f32 v138, v138, v25
  v_mul_f32 v139, v139, v26
  v_cvt_pk_bf16_f32 v24, v138, v139
  v_lshlrev_b32 v138, 16, v24
  v_and_b32 v139, 0xffff0000, v24
  v_lshlrev_b32 v25, 16, v145
  v_and_b32 v26, 0xffff0000, v145
  v_add_f32 v138, v138, v25
  v_add_f32 v139, v139, v26
  v_cvt_pk_bf16_f32 v29, v138, v139
  v_lshlrev_b32 v138, 16, v29
  v_and_b32 v139, 0xffff0000, v29
  v_min_u32 v28, 0xfffeffff, v28
  v_min_u32 v29, 0xfffeffff, v29
  v_lshlrev_b32 v6, 3, v0
  s_sub_u32 s56, s2, 211
  s_lshl_b32 s56, s56, 9
  s_add_u32 s56, s56, 524288
  buffer_store_dwordx2 v[28:29], v6, s[36:39], s56 offen sc1
  s_mov_b32 s61, 0x07060302
Lfin_70:
  v_lshrrev_b32 v4, 3, v2
  v_lshlrev_b32 v4, 6, v4
  v_lshl_add_u32 v4, v3, 7, v4
  v_lshl_add_u32 v4, v1, 4, v4
  s_lshl_b32 s56, s3, 10
  s_add_u32 s56, s56, 491520
  s_add_u32 s57, s3, 24
  s_min_u32 s57, s57, 26
  s_lshl_b32 s57, s57, 10
  s_add_u32 s57, s57, 491520
  s_add_u32 s62, s56, 4096
  s_add_u32 s63, s56, 8192
  s_add_u32 s64, s56, 12288
  s_add_u32 s65, s56, 16384
  s_add_u32 s66, s56, 20480
Lpoll_73:
  buffer_load_dwordx4 v[8:11], v4, s[36:39], s56 offen sc1
  buffer_load_dwordx4 v[12:15], v4, s[36:39], s62 offen sc1
  buffer_load_dwordx4 v[16:19], v4, s[36:39], s63 offen sc1
  buffer_load_dwordx4 v[20:23], v4, s[36:39], s64 offen sc1
  buffer_load_dwordx4 v[24:27], v4, s[36:39], s65 offen sc1
  buffer_load_dwordx4 v[28:31], v4, s[36:39], s66 offen sc1
  buffer_load_dwordx4 v[32:35], v4, s[36:39], s57 offen sc1
  s_waitcnt vmcnt(0)
  v_cmp_eq_u32 vcc, -1, v8
  v_cmp_eq_u32 s[58:59], -1, v9
  s_or_b64 vcc, vcc, s[58:59]
  v_cmp_eq_u32 s[58:59], -1, v10
  s_or_b64 vcc, vcc, s[58:59]
  v_cmp_eq_u32 s[58:59], -1, v11
  s_or_b64 vcc, vcc, s[58:59]
  v_cmp_eq_u32 s[58:59], -1, v12
  s_or_b64 vcc, vcc, s[58:59]
  v_cmp_eq_u32 s[58:59], -1, v13
  s_or_b64 vcc, vcc, s[58:59]
  v_cmp_eq_u32 s[58:59], -1, v14
  s_or_b64 vcc, vcc, s[58:59]
  v_cmp_eq_u32 s[58:59], -1, v15
  s_or_b64 vcc, vcc, s[58:59]
  v_cmp_eq_u32 s[58:59], -1, v16
  s_or_b64 vcc, vcc, s[58:59]
  v_cmp_eq_u32 s[58:59], -1, v17
  s_or_b64 vcc, vcc, s[58:59]
  v_cmp_eq_u32 s[58:59], -1, v18
  s_or_b64 vcc, vcc, s[58:59]
  v_cmp_eq_u32 s[58:59], -1, v19
  s_or_b64 vcc, vcc, s[58:59]
  v_cmp_eq_u32 s[58:59], -1, v20
  s_or_b64 vcc, vcc, s[58:59]
  v_cmp_eq_u32 s[58:59], -1, v21
  s_or_b64 vcc, vcc, s[58:59]
  v_cmp_eq_u32 s[58:59], -1, v22
  s_or_b64 vcc, vcc, s[58:59]
  v_cmp_eq_u32 s[58:59], -1, v23
  s_or_b64 vcc, vcc, s[58:59]
  v_cmp_eq_u32 s[58:59], -1, v24
  s_or_b64 vcc, vcc, s[58:59]
  v_cmp_eq_u32 s[58:59], -1, v25
  s_or_b64 vcc, vcc, s[58:59]
  v_cmp_eq_u32 s[58:59], -1, v26
  s_or_b64 vcc, vcc, s[58:59]
  v_cmp_eq_u32 s[58:59], -1, v27
  s_or_b64 vcc, vcc, s[58:59]
  v_cmp_eq_u32 s[58:59], -1, v28
  s_or_b64 vcc, vcc, s[58:59]
  v_cmp_eq_u32 s[58:59], -1, v29
  s_or_b64 vcc, vcc, s[58:59]
  v_cmp_eq_u32 s[58:59], -1, v30
  s_or_b64 vcc, vcc, s[58:59]
  v_cmp_eq_u32 s[58:59], -1, v31
  s_or_b64 vcc, vcc, s[58:59]
  v_cmp_eq_u32 s[58:59], -1, v32
  s_or_b64 vcc, vcc, s[58:59]
  v_cmp_eq_u32 s[58:59], -1, v33
  s_or_b64 vcc, vcc, s[58:59]
  v_cmp_eq_u32 s[58:59], -1, v34
  s_or_b64 vcc, vcc, s[58:59]
  v_cmp_eq_u32 s[58:59], -1, v35
  s_or_b64 vcc, vcc, s[58:59]
  s_cbranch_vccz Lpd_74
  s_add_u32 s30, s30, 1
  s_cmp_gt_u32 s30, 400000
  s_cbranch_scc0 Lpoll_73
Lpd_74:
  v_mfma_f32_16x16x32_bf16 v[152:155], v[8:11], v[40:43], 0
  v_mfma_f32_16x16x32_bf16 v[156:159], v[8:11], v[44:47], 0
  v_mfma_f32_16x16x32_bf16 v[160:163], v[8:11], v[48:51], 0
  v_mfma_f32_16x16x32_bf16 v[164:167], v[8:11], v[52:55], 0
  v_mfma_f32_16x16x32_bf16 v[152:155], v[12:15], v[56:59], v[152:155]
  v_mfma_f32_16x16x32_bf16 v[156:159], v[12:15], v[60:63], v[156:159]
  v_mfma_f32_16x16x32_bf16 v[160:163], v[12:15], v[64:67], v[160:163]
  v_mfma_f32_16x16x32_bf16 v[164:167], v[12:15], v[68:71], v[164:167]
  v_mfma_f32_16x16x32_bf16 v[152:155], v[16:19], v[72:75], v[152:155]
  v_mfma_f32_16x16x32_bf16 v[156:159], v[16:19], v[76:79], v[156:159]
  v_mfma_f32_16x16x32_bf16 v[160:163], v[16:19], v[80:83], v[160:163]
  v_mfma_f32_16x16x32_bf16 v[164:167], v[16:19], v[84:87], v[164:167]
  v_mfma_f32_16x16x32_bf16 v[152:155], v[20:23], v[88:91], v[152:155]
  v_mfma_f32_16x16x32_bf16 v[156:159], v[20:23], v[92:95], v[156:159]
  v_mfma_f32_16x16x32_bf16 v[160:163], v[20:23], v[96:99], v[160:163]
  v_mfma_f32_16x16x32_bf16 v[164:167], v[20:23], v[100:103], v[164:167]
  v_mfma_f32_16x16x32_bf16 v[152:155], v[24:27], v[104:107], v[152:155]
  v_mfma_f32_16x16x32_bf16 v[156:159], v[24:27], v[108:111], v[156:159]
  v_mfma_f32_16x16x32_bf16 v[160:163], v[24:27], v[112:115], v[160:163]
  v_mfma_f32_16x16x32_bf16 v[164:167], v[24:27], v[116:119], v[164:167]
  v_mfma_f32_16x16x32_bf16 v[152:155], v[28:31], v[120:123], v[152:155]
  v_mfma_f32_16x16x32_bf16 v[156:159], v[28:31], v[124:127], v[156:159]
  v_mfma_f32_16x16x32_bf16 v[160:163], v[28:31], v[128:131], v[160:163]
  v_mfma_f32_16x16x32_bf16 v[164:167], v[28:31], v[132:135], v[164:167]
  s_cmp_eq_u32 s3, 3
  s_cbranch_scc1 Lsk7_75
  v_mfma_f32_16x16x32_bf16 v[152:155], v[32:35], v[136:139], v[152:155]
  v_mfma_f32_16x16x32_bf16 v[156:159], v[32:35], v[140:143], v[156:159]
  v_mfma_f32_16x16x32_bf16 v[160:163], v[32:35], v[144:147], v[160:163]
  v_mfma_f32_16x16x32_bf16 v[164:167], v[32:35], v[148:151], v[164:167]
Lsk7_75:
  v_lshrrev_b32 v6, 1, v1
  v_lshlrev_b32 v6, 10, v6
  v_and_b32 v7, 1, v1
  v_lshl_add_u32 v6, v7, 9, v6
  v_lshl_add_u32 v6, v2, 3, v6
  s_lshl_b32 s56, s3, 11
  v_add_u32 v6, s56, v6
  s_mov_b32 s58, 0
  s_mov_b32 s59, -1
  s_nop 3
  v_cndmask_b32 v56, v152, v160, s[58:59]
  v_cndmask_b32 v57, v156, v164, s[58:59]
  v_cndmask_b32 v58, v153, v161, s[58:59]
  v_cndmask_b32 v59, v157, v165, s[58:59]
  v_cndmask_b32 v60, v154, v162, s[58:59]
  v_cndmask_b32 v61, v158, v166, s[58:59]
  v_cndmask_b32 v62, v155, v163, s[58:59]
  v_cndmask_b32 v63, v159, v167, s[58:59]
  ds_write_b64 v6, v[56:57] offset:0
  ds_write_b64 v6, v[58:59] offset:128
  ds_write_b64 v6, v[60:61] offset:256
  ds_write_b64 v6, v[62:63] offset:384
  s_waitcnt lgkmcnt(0)
  s_barrier
  s_cmp_lg_u32 s3, 3
  s_cbranch_scc1 L_END
  v_lshlrev_b32 v6, 4, v0
  ds_read_b128 v[8:11], v6 offset:0
  ds_read_b128 v[12:15], v6 offset:1024
  ds_read_b128 v[16:19], v6 offset:2048
  ds_read_b128 v[20:23], v6 offset:3072
  ds_read_b128 v[24:27], v6 offset:4096
  ds_read_b128 v[28:31], v6 offset:5120
  ds_read_b128 v[32:35], v6 offset:6144
  ds_read_b128 v[36:39], v6 offset:7168
  s_waitcnt lgkmcnt(0)
  v_add_f32 v8, v8, v12
  v_add_f32 v16, v16, v20
  v_add_f32 v24, v24, v28
  v_add_f32 v32, v32, v36
  v_add_f32 v8, v8, v16
  v_add_f32 v24, v24, v32
  v_add_f32 v64, v8, v24
  v_add_f32 v9, v9, v13
  v_add_f32 v17, v17, v21
  v_add_f32 v25, v25, v29
  v_add_f32 v33, v33, v37
  v_add_f32 v9, v9, v17
  v_add_f32 v25, v25, v33
  v_add_f32 v65, v9, v25
  v_add_f32 v10, v10, v14
  v_add_f32 v18, v18, v22
  v_add_f32 v26, v26, v30
  v_add_f32 v34, v34, v38
  v_add_f32 v10, v10, v18
  v_add_f32 v26, v26, v34
  v_add_f32 v66, v10, v26
  v_add_f32 v11, v11, v15
  v_add_f32 v19, v19, v23
  v_add_f32 v27, v27, v31
  v_add_f32 v35, v35, v39
  v_add_f32 v11, v11, v19
  v_add_f32 v27, v27, v35
  v_add_f32 v67, v11, v27
  v_cvt_pk_bf16_f32 v70, v64, v65
  v_lshlrev_b32 v64, 16, v70
  v_and_b32 v65, 0xffff0000, v70
  v_lshlrev_b32 v71, 16, v148
  v_and_b32 v72, 0xffff0000, v148
  v_mul_f32 v64, v64, v71
  v_mul_f32 v65, v65, v72
  v_cvt_pk_bf16_f32 v70, v64, v65
  v_lshlrev_b32 v64, 16, v70
  v_and_b32 v65, 0xffff0000, v70
  v_add_f32 v136, v136, v64
  v_add_f32 v137, v137, v65
  v_cvt_pk_bf16_f32 v74, v136, v137
  v_cvt_pk_bf16_f32 v70, v66, v67
  v_lshlrev_b32 v66, 16, v70
  v_and_b32 v67, 0xffff0000, v70
  v_lshlrev_b32 v71, 16, v149
  v_and_b32 v72, 0xffff0000, v149
  v_mul_f32 v66, v66, v71
  v_mul_f32 v67, v67, v72
  v_cvt_pk_bf16_f32 v70, v66, v67
  v_lshlrev_b32 v66, 16, v70
  v_and_b32 v67, 0xffff0000, v70
  v_add_f32 v138, v138, v66
  v_add_f32 v139, v139, v67
  v_cvt_pk_bf16_f32 v75, v138, v139
  s_mov_b32 s48, s28
  s_mov_b32 s49, s29
  s_mov_b32 s50, 10240
  s_mov_b32 s51, 0x20000
  v_lshrrev_b32 v6, 3, v0
  s_movk_i32 s57, 1280
  v_mul_lo_u32 v6, v6, s57
  v_and_b32 v7, 7, v0
  v_lshl_add_u32 v6, v7, 3, v6
  s_sub_u32 s56, s2, 211
  s_lshl_b32 s56, s56, 6
  buffer_store_dwordx2 v[74:75], v6, s[48:51], s56 offen
  s_branch L_END
L_STREAM:
  s_setprio 2
  s_sub_u32 s3, s3, 4
  v_lshlrev_b32 v4, 8, v2
  v_lshl_add_u32 v4, v1, 4, v4
  v_lshlrev_b32 v1, 10, v1
  v_lshl_add_u32 v1, v2, 4, v1
  v_mov_b32 v0, v4
  s_waitcnt lgkmcnt(0)
  s_lshl_b32 s56, s78, 20
  s_lshr_b32 s57, s78, 12
  s_add_u32 s36, s10, s56
  s_addc_u32 s37, s11, s57
  s_mov_b32 s38, 0x100000
  s_mov_b32 s39, 0x20000
  s_add_u32 s40, s12, s56
  s_addc_u32 s41, s13, s57
  s_mov_b32 s42, 0x100000
  s_mov_b32 s43, 0x20000
  s_lshl_b32 s44, s3, 13
  s_add_u32 s45, s44, 65536
  s_add_u32 s47, s44, 131072
  s_lshl_b32 s54, s3, 14
  s_add_u32 s54, s54, 24576
  s_add_u32 s46, s44, 4096
  s_waitcnt vmcnt(11)
  buffer_load_dwordx4 v[40:43], v0, s[36:39], s44 offen offset:0 nt
  s_waitcnt vmcnt(11)
  buffer_load_dwordx4 v[44:47], v0, s[36:39], s44 offen offset:64 nt
  s_barrier
  s_waitcnt vmcnt(11)
  buffer_load_dwordx4 v[48:51], v0, s[36:39], s44 offen offset:128 nt
  s_waitcnt vmcnt(11)
  buffer_load_dwordx4 v[52:55], v0, s[36:39], s44 offen offset:192 nt
  s_waitcnt vmcnt(11)
  buffer_load_dwordx4 v[56:59], v0, s[36:39], s46 offen offset:0 nt
  s_waitcnt vmcnt(11)
  buffer_load_dwordx4 v[60:63], v0, s[36:39], s46 offen offset:64 nt
  s_waitcnt vmcnt(11)
  buffer_load_dwordx4 v[64:67], v0, s[36:39], s46 offen offset:128 nt
  s_waitcnt vmcnt(11)
  buffer_load_dwordx4 v[68:71], v0, s[36:39], s46 offen offset:192 nt
  s_add_u32 s46, s44, 4096
  s_waitcnt vmcnt(11)
  buffer_load_dwordx4 v[72:75], v1, s[40:43], s44 offen offset:0 nt
  s_waitcnt vmcnt(11)
  buffer_load_dwordx4 v[76:79], v1, s[40:43], s44 offen offset:256 nt
  s_waitcnt vmcnt(11)
  buffer_load_dwordx4 v[80:83], v1, s[40:43], s44 offen offset:512 nt
  s_waitcnt vmcnt(11)
  buffer_load_dwordx4 v[84:87], v1, s[40:43], s44 offen offset:768 nt
  s_waitcnt vmcnt(11)
  buffer_load_dwordx4 v[88:91], v1, s[40:43], s46 offen offset:0 nt
  s_waitcnt vmcnt(11)
  buffer_load_dwordx4 v[92:95], v1, s[40:43], s46 offen offset:256 nt
  s_waitcnt vmcnt(11)
  buffer_load_dwordx4 v[96:99], v1, s[40:43], s46 offen offset:512 nt
  s_waitcnt vmcnt(11)
  buffer_load_dwordx4 v[100:103], v1, s[40:43], s46 offen offset:768 nt
  s_add_u32 s46, s47, 4096
  s_add_u32 m0, s54, 0
  s_waitcnt vmcnt(11)
  buffer_load_dwordx4 v0, s[36:39], s47 offen offset:0 nt lds
  s_add_u32 m0, s54, 960
  s_waitcnt vmcnt(11)
  buffer_load_dwordx4 v0, s[36:39], s47 offen offset:64 nt lds
  s_add_u32 m0, s54, 1920
  s_waitcnt vmcnt(11)
  buffer_load_dwordx4 v0, s[36:39], s47 offen offset:128 nt lds
  s_add_u32 m0, s54, 2880
  s_waitcnt vmcnt(11)
  buffer_load_dwordx4 v0, s[36:39], s47 offen offset:192 nt lds
  s_add_u32 m0, s54, 4096
  s_waitcnt vmcnt(11)
  buffer_load_dwordx4 v0, s[36:39], s46 offen offset:0 nt lds
  s_add_u32 m0, s54, 5056
  s_waitcnt vmcnt(11)
  buffer_load_dwordx4 v0, s[36:39], s46 offen offset:64 nt lds
  s_add_u32 m0, s54, 6016
  s_waitcnt vmcnt(11)
  buffer_load_dwordx4 v0, s[36:39], s46 offen offset:128 nt lds
  s_add_u32 m0, s54, 6976
  s_waitcnt vmcnt(11)
  buffer_load_dwordx4 v0, s[36:39], s46 offen offset:192 nt lds
  s_add_u32 s46, s47, 4096
  s_add_u32 m0, s54, 8192
  s_waitcnt vmcnt(11)
  buffer_load_dwordx4 v1, s[40:43], s47 offen offset:0 nt lds
  s_add_u32 m0, s54, 8960
  s_waitcnt vmcnt(11)
  buffer_load_dwordx4 v1, s[40:43], s47 offen offset:256 nt lds
  s_add_u32 m0, s54, 9728
  s_waitcnt vmcnt(11)
  buffer_load_dwordx4 v1, s[40:43], s47 offen offset:512 nt lds
  s_add_u32 m0, s54, 10496
  s_waitcnt vmcnt(11)
  buffer_load_dwordx4 v1, s[40:43], s47 offen offset:768 nt lds
  s_add_u32 m0, s54, 12288
  s_waitcnt vmcnt(11)
  buffer_load_dwordx4 v1, s[40:43], s46 offen offset:0 nt lds
  s_add_u32 m0, s54, 13056
  s_waitcnt vmcnt(11)
  buffer_load_dwordx4 v1, s[40:43], s46 offen offset:256 nt lds
  s_add_u32 m0, s54, 13824
  s_waitcnt vmcnt(11)
  buffer_load_dwordx4 v1, s[40:43], s46 offen offset:512 nt lds
  s_add_u32 m0, s54, 14592
  s_waitcnt vmcnt(11)
  buffer_load_dwordx4 v1, s[40:43], s46 offen offset:768 nt lds
  s_add_u32 s46, s45, 4096
  s_waitcnt vmcnt(11)
  buffer_load_dwordx4 v[104:107], v0, s[36:39], s45 offen offset:0 nt
  s_waitcnt vmcnt(11)
  buffer_load_dwordx4 v[108:111], v0, s[36:39], s45 offen offset:64 nt
  s_waitcnt vmcnt(11)
  buffer_load_dwordx4 v[112:115], v0, s[36:39], s45 offen offset:128 nt
  s_waitcnt vmcnt(11)
  buffer_load_dwordx4 v[116:119], v0, s[36:39], s45 offen offset:192 nt
  s_waitcnt vmcnt(11)
  buffer_load_dwordx4 v[120:123], v0, s[36:39], s46 offen offset:0 nt
  s_waitcnt vmcnt(11)
  buffer_load_dwordx4 v[124:127], v0, s[36:39], s46 offen offset:64 nt
  s_waitcnt vmcnt(11)
  buffer_load_dwordx4 v[128:131], v0, s[36:39], s46 offen offset:128 nt
  s_waitcnt vmcnt(11)
  buffer_load_dwordx4 v[132:135], v0, s[36:39], s46 offen offset:192 nt
  s_add_u32 s46, s45, 4096
  s_waitcnt vmcnt(11)
  buffer_load_dwordx4 v[136:139], v1, s[40:43], s45 offen offset:0 nt
  s_waitcnt vmcnt(11)
  buffer_load_dwordx4 v[140:143], v1, s[40:43], s45 offen offset:256 nt
  s_waitcnt vmcnt(11)
  buffer_load_dwordx4 v[144:147], v1, s[40:43], s45 offen offset:512 nt
  s_waitcnt vmcnt(11)
  buffer_load_dwordx4 v[148:151], v1, s[40:43], s45 offen offset:768 nt
  s_waitcnt vmcnt(11)
  buffer_load_dwordx4 v[152:155], v1, s[40:43], s46 offen offset:0 nt
  s_waitcnt vmcnt(11)
  buffer_load_dwordx4 v[156:159], v1, s[40:43], s46 offen offset:256 nt
  s_waitcnt vmcnt(11)
  buffer_load_dwordx4 v[160:163], v1, s[40:43], s46 offen offset:512 nt
  s_waitcnt vmcnt(11)
  buffer_load_dwordx4 v[164:167], v1, s[40:43], s46 offen offset:768 nt
  s_mov_b32 s62, 0x10001
  s_mov_b32 s63, 0x10001
  s_mov_b32 s64, 0x20002
  s_mov_b32 s65, 0x20002
  s_mov_b32 s66, 0x40004
  s_mov_b32 s67, 0x40004
  s_mov_b32 s68, 0x80008
  s_mov_b32 s69, 0x80008
  s_mov_b32 s70, 0x100010
  s_mov_b32 s71, 0x100010
  s_mov_b32 s72, 0x200020
  s_mov_b32 s73, 0x200020
  s_mov_b32 s74, 0x400040
  s_mov_b32 s75, 0x400040
  s_mov_b32 s76, 0x800080
  s_mov_b32 s77, 0x800080
  s_mov_b32 s60, 0x05040100
  s_mov_b32 s61, 0x07060302
  s_mov_b32 s52, 0x3e0293ee
  s_mov_b32 s53, 0x3f803f80
  s_mov_b32 s48, 0xff800000
  s_mov_b32 s49, 0
  v_mov_b32 v4, 0
  v_mov_b32 v5, 0
  v_mov_b32 v6, 0
  v_mov_b32 v7, 0
  v_mov_b32 v2, 0
  v_mov_b32 v16, 0
Lqr_76:
  ds_read_b32 v17, v16 offset:16664
  s_waitcnt lgkmcnt(0)
  v_readfirstlane_b32 s56, v17
  s_nop 1
  s_cmp_lg_u32 s56, 0
  s_cbranch_scc1 Lqd_77
  s_sleep 2
  s_branch Lqr_76
Lqd_77:
  v_mbcnt_lo_u32_b32 v16, -1, 0
  v_mbcnt_hi_u32_b32 v16, -1, v16
  v_lshrrev_b32 v16, 4, v16
  v_lshlrev_b32 v16, 4, v16
  ds_read_b128 v[24:27], v16 offset:16384
  ds_read_b128 v[28:31], v16 offset:16448
  ds_read_b128 v[32:35], v16 offset:16512
  ds_read_b128 v[36:39], v16 offset:16576
  s_setprio 0
  v_mov_b32 v16, 16656
  v_mov_b32 v17, 1
  s_mov_b64 exec, 1
  ds_add_rtn_u32 v3, v16, v17
  s_mov_b64 exec, -1
  s_waitcnt vmcnt(40) lgkmcnt(0)
  v_mfma_f32_16x16x32_bf16 v[8:11], v[40:43], v[24:27], 0
  v_mfma_f32_16x16x32_bf16 v[12:15], v[56:59], v[24:27], 0
  v_mfma_f32_16x16x32_bf16 v[8:11], v[44:47], v[28:31], v[8:11]
  v_mfma_f32_16x16x32_bf16 v[12:15], v[60:63], v[28:31], v[12:15]
  v_mfma_f32_16x16x32_bf16 v[8:11], v[48:51], v[32:35], v[8:11]
  v_mfma_f32_16x16x32_bf16 v[12:15], v[64:67], v[32:35], v[12:15]
  v_mfma_f32_16x16x32_bf16 v[8:11], v[52:55], v[36:39], v[8:11]
  v_mfma_f32_16x16x32_bf16 v[12:15], v[68:71], v[36:39], v[12:15]
  v_mbcnt_lo_u32_b32 v16, -1, 0
  v_mbcnt_hi_u32_b32 v16, -1, v16
  v_lshlrev_b32 v16, 4, v16
  v_add_u32 v16, s54, v16
  s_waitcnt vmcnt(24)
  ds_read_b128 v[40:43], v16 offset:0
  ds_read_b128 v[44:47], v16 offset:1024
  ds_read_b128 v[48:51], v16 offset:2048
  ds_read_b128 v[52:55], v16 offset:3072
  ds_read_b128 v[56:59], v16 offset:4096
  ds_read_b128 v[60:63], v16 offset:5120
  ds_read_b128 v[64:67], v16 offset:6144
  ds_read_b128 v[68:71], v16 offset:7168
  v_max3_f32 v17, v8, v9, v10
  v_max3_f32 v17, v17, v11, v12
  v_max3_f32 v17, v17, v13, v14
  v_max_f32 v17, v17, v15
  v_cmp_lt_f32 vcc, s48, v17
  s_cbranch_vccnz L_RAREa
L_CONTa:
  v_mov_b32 v16, s49
  v_fma_f32 v8, v8, s52, v16
  v_fma_f32 v9, v9, s52, v16
  v_fma_f32 v10, v10, s52, v16
  v_fma_f32 v11, v11, s52, v16
  v_fma_f32 v12, v12, s52, v16
  v_fma_f32 v13, v13, s52, v16
  v_fma_f32 v14, v14, s52, v16
  v_fma_f32 v15, v15, s52, v16
  v_exp_f32 v8, v8
  v_exp_f32 v9, v9
  v_exp_f32 v10, v10
  v_exp_f32 v11, v11
  v_exp_f32 v12, v12
  v_exp_f32 v13, v13
  v_exp_f32 v14, v14
  v_exp_f32 v15, v15
  v_cvt_pk_bf16_f32 v8, v8, v9
  v_cvt_pk_bf16_f32 v9, v10, v11
  v_cvt_pk_bf16_f32 v10, v12, v13
  v_cvt_pk_bf16_f32 v11, v14, v15
  s_waitcnt vmcnt(24)
  v_perm_b32 v16, v76, v72, s60
  v_perm_b32 v17, v84, v80, s60
  v_perm_b32 v18, v92, v88, s60
  v_perm_b32 v19, v100, v96, s60
  v_dot2_f32_bf16 v2, v8, s53, v2
  v_dot2_f32_bf16 v2, v9, s53, v2
  v_dot2_f32_bf16 v2, v10, s53, v2
  v_dot2_f32_bf16 v2, v11, s53, v2
  v_cndmask_b32 v12, 0, v8, s[62:63]
  v_cndmask_b32 v13, 0, v9, s[62:63]
  v_cndmask_b32 v14, 0, v10, s[62:63]
  v_cndmask_b32 v15, 0, v11, s[62:63]
  v_perm_b32 v20, v76, v72, s61
  v_perm_b32 v21, v84, v80, s61
  v_perm_b32 v22, v92, v88, s61
  v_perm_b32 v23, v100, v96, s61
  v_mfma_f32_16x16x32_bf16 v[4:7], v[12:15], v[16:19], v[4:7]
  v_cndmask_b32 v12, 0, v8, s[64:65]
  v_cndmask_b32 v13, 0, v9, s[64:65]
  v_cndmask_b32 v14, 0, v10, s[64:65]
  v_cndmask_b32 v15, 0, v11, s[64:65]
  v_perm_b32 v16, v77, v73, s60
  v_perm_b32 v17, v85, v81, s60
  v_perm_b32 v18, v93, v89, s60
  v_perm_b32 v19, v101, v97, s60
  v_mfma_f32_16x16x32_bf16 v[4:7], v[12:15], v[20:23], v[4:7]
  v_cndmask_b32 v12, 0, v8, s[66:67]
  v_cndmask_b32 v13, 0, v9, s[66:67]
  v_cndmask_b32 v14, 0, v10, s[66:67]
  v_cndmask_b32 v15, 0, v11, s[66:67]
  v_perm_b32 v20, v77, v73, s61
  v_perm_b32 v21, v85, v81, s61
  v_perm_b32 v22, v93, v89, s61
  v_perm_b32 v23, v101, v97, s61
  v_mfma_f32_16x16x32_bf16 v[4:7], v[12:15], v[16:19], v[4:7]
  v_cndmask_b32 v12, 0, v8, s[68:69]
  v_cndmask_b32 v13, 0, v9, s[68:69]
  v_cndmask_b32 v14, 0, v10, s[68:69]
  v_cndmask_b32 v15, 0, v11, s[68:69]
  v_perm_b32 v16, v78, v74, s60
  v_perm_b32 v17, v86, v82, s60
  v_perm_b32 v18, v94, v90, s60
  v_perm_b32 v19, v102, v98, s60
  v_mfma_f32_16x16x32_bf16 v[4:7], v[12:15], v[20:23], v[4:7]
  v_cndmask_b32 v12, 0, v8, s[70:71]
  v_cndmask_b32 v13, 0, v9, s[70:71]
  v_cndmask_b32 v14, 0, v10, s[70:71]
  v_cndmask_b32 v15, 0, v11, s[70:71]
  v_perm_b32 v20, v78, v74, s61
  v_perm_b32 v21, v86, v82, s61
  v_perm_b32 v22, v94, v90, s61
  v_perm_b32 v23, v102, v98, s61
  v_mfma_f32_16x16x32_bf16 v[4:7], v[12:15], v[16:19], v[4:7]
  v_cndmask_b32 v12, 0, v8, s[72:73]
  v_cndmask_b32 v13, 0, v9, s[72:73]
  v_cndmask_b32 v14, 0, v10, s[72:73]
  v_cndmask_b32 v15, 0, v11, s[72:73]
  v_perm_b32 v16, v79, v75, s60
  v_perm_b32 v17, v87, v83, s60
  v_perm_b32 v18, v95, v91, s60
  v_perm_b32 v19, v103, v99, s60
  v_mfma_f32_16x16x32_bf16 v[4:7], v[12:15], v[20:23], v[4:7]
  v_cndmask_b32 v12, 0, v8, s[74:75]
  v_cndmask_b32 v13, 0, v9, s[74:75]
  v_cndmask_b32 v14, 0, v10, s[74:75]
  v_cndmask_b32 v15, 0, v11, s[74:75]
  v_perm_b32 v20, v79, v75, s61
  v_perm_b32 v21, v87, v83, s61
  v_perm_b32 v22, v95, v91, s61
  v_perm_b32 v23, v103, v99, s61
  v_mfma_f32_16x16x32_bf16 v[4:7], v[12:15], v[16:19], v[4:7]
  v_cndmask_b32 v12, 0, v8, s[76:77]
  v_cndmask_b32 v13, 0, v9, s[76:77]
  v_cndmask_b32 v14, 0, v10, s[76:77]
  v_cndmask_b32 v15, 0, v11, s[76:77]
  s_nop 1
  v_mfma_f32_16x16x32_bf16 v[4:7], v[12:15], v[20:23], v[4:7]
  v_mbcnt_lo_u32_b32 v16, -1, 0
  v_mbcnt_hi_u32_b32 v16, -1, v16
  v_lshlrev_b32 v16, 4, v16
  v_add_u32 v16, s54, v16
  s_waitcnt vmcnt(16)
  ds_read_b128 v[72:75], v16 offset:8192
  ds_read_b128 v[76:79], v16 offset:9216
  ds_read_b128 v[80:83], v16 offset:10240
  ds_read_b128 v[84:87], v16 offset:11264
  ds_read_b128 v[88:91], v16 offset:12288
  ds_read_b128 v[92:95], v16 offset:13312
  ds_read_b128 v[96:99], v16 offset:14336
  ds_read_b128 v[100:103], v16 offset:15360
  s_waitcnt vmcnt(8) lgkmcnt(0)
  v_mfma_f32_16x16x32_bf16 v[8:11], v[104:107], v[24:27], 0
  v_mfma_f32_16x16x32_bf16 v[12:15], v[120:123], v[24:27], 0
  v_readfirstlane_b32 s45, v3
  v_mfma_f32_16x16x32_bf16 v[8:11], v[108:111], v[28:31], v[8:11]
  v_mfma_f32_16x16x32_bf16 v[12:15], v[124:127], v[28:31], v[12:15]
  v_mfma_f32_16x16x32_bf16 v[8:11], v[112:115], v[32:35], v[8:11]
  v_mfma_f32_16x16x32_bf16 v[12:15], v[128:131], v[32:35], v[12:15]
  v_mfma_f32_16x16x32_bf16 v[8:11], v[116:119], v[36:39], v[8:11]
  v_mfma_f32_16x16x32_bf16 v[12:15], v[132:135], v[36:39], v[12:15]
  s_lshl_b32 s45, s45, 13
  s_add_u32 s46, s45, 4096
  buffer_load_dwordx4 v[104:107], v0, s[36:39], s45 offen offset:0 nt
  buffer_load_dwordx4 v[108:111], v0, s[36:39], s45 offen offset:64 nt
  buffer_load_dwordx4 v[112:115], v0, s[36:39], s45 offen offset:128 nt
  buffer_load_dwordx4 v[116:119], v0, s[36:39], s45 offen offset:192 nt
  buffer_load_dwordx4 v[120:123], v0, s[36:39], s46 offen offset:0 nt
  buffer_load_dwordx4 v[124:127], v0, s[36:39], s46 offen offset:64 nt
  buffer_load_dwordx4 v[128:131], v0, s[36:39], s46 offen offset:128 nt
  buffer_load_dwordx4 v[132:135], v0, s[36:39], s46 offen offset:192 nt
  v_mov_b32 v16, 16656
  v_mov_b32 v17, 1
  s_mov_b64 exec, 1
  ds_add_rtn_u32 v3, v16, v17
  s_mov_b64 exec, -1
  v_max3_f32 v17, v8, v9, v10
  v_max3_f32 v17, v17, v11, v12
  v_max3_f32 v17, v17, v13, v14
  v_max_f32 v17, v17, v15
  v_cmp_lt_f32 vcc, s48, v17
  s_cbranch_vccnz L_RAREb
L_CONTb:
  v_mov_b32 v16, s49
  v_fma_f32 v8, v8, s52, v16
  v_fma_f32 v9, v9, s52, v16
  v_fma_f32 v10, v10, s52, v16
  v_fma_f32 v11, v11, s52, v16
  v_fma_f32 v12, v12, s52, v16
  v_fma_f32 v13, v13, s52, v16
  v_fma_f32 v14, v14, s52, v16
  v_fma_f32 v15, v15, s52, v16
  v_exp_f32 v8, v8
  v_exp_f32 v9, v9
  v_exp_f32 v10, v10
  v_exp_f32 v11, v11
  v_exp_f32 v12, v12
  v_exp_f32 v13, v13
  v_exp_f32 v14, v14
  v_exp_f32 v15, v15
  v_cvt_pk_bf16_f32 v8, v8, v9
  v_cvt_pk_bf16_f32 v9, v10, v11
  v_cvt_pk_bf16_f32 v10, v12, v13
  v_cvt_pk_bf16_f32 v11, v14, v15
  s_waitcnt vmcnt(8)
  v_perm_b32 v16, v140, v136, s60
  v_perm_b32 v17, v148, v144, s60
  v_perm_b32 v18, v156, v152, s60
  v_perm_b32 v19, v164, v160, s60
  v_dot2_f32_bf16 v2, v8, s53, v2
  v_dot2_f32_bf16 v2, v9, s53, v2
  v_dot2_f32_bf16 v2, v10, s53, v2
  v_dot2_f32_bf16 v2, v11, s53, v2
  v_cndmask_b32 v12, 0, v8, s[62:63]
  v_cndmask_b32 v13, 0, v9, s[62:63]
  v_cndmask_b32 v14, 0, v10, s[62:63]
  v_cndmask_b32 v15, 0, v11, s[62:63]
  v_perm_b32 v20, v140, v136, s61
  v_perm_b32 v21, v148, v144, s61
  v_perm_b32 v22, v156, v152, s61
  v_perm_b32 v23, v164, v160, s61
  v_mfma_f32_16x16x32_bf16 v[4:7], v[12:15], v[16:19], v[4:7]
  v_cndmask_b32 v12, 0, v8, s[64:65]
  v_cndmask_b32 v13, 0, v9, s[64:65]
  v_cndmask_b32 v14, 0, v10, s[64:65]
  v_cndmask_b32 v15, 0, v11, s[64:65]
  v_perm_b32 v16, v141, v137, s60
  v_perm_b32 v17, v149, v145, s60
  v_perm_b32 v18, v157, v153, s60
  v_perm_b32 v19, v165, v161, s60
  v_mfma_f32_16x16x32_bf16 v[4:7], v[12:15], v[20:23], v[4:7]
  v_cndmask_b32 v12, 0, v8, s[66:67]
  v_cndmask_b32 v13, 0, v9, s[66:67]
  v_cndmask_b32 v14, 0, v10, s[66:67]
  v_cndmask_b32 v15, 0, v11, s[66:67]
  v_perm_b32 v20, v141, v137, s61
  v_perm_b32 v21, v149, v145, s61
  v_perm_b32 v22, v157, v153, s61
  v_perm_b32 v23, v165, v161, s61
  v_mfma_f32_16x16x32_bf16 v[4:7], v[12:15], v[16:19], v[4:7]
  v_cndmask_b32 v12, 0, v8, s[68:69]
  v_cndmask_b32 v13, 0, v9, s[68:69]
  v_cndmask_b32 v14, 0, v10, s[68:69]
  v_cndmask_b32 v15, 0, v11, s[68:69]
  v_perm_b32 v16, v142, v138, s60
  v_perm_b32 v17, v150, v146, s60
  v_perm_b32 v18, v158, v154, s60
  v_perm_b32 v19, v166, v162, s60
  v_mfma_f32_16x16x32_bf16 v[4:7], v[12:15], v[20:23], v[4:7]
  v_cndmask_b32 v12, 0, v8, s[70:71]
  v_cndmask_b32 v13, 0, v9, s[70:71]
  v_cndmask_b32 v14, 0, v10, s[70:71]
  v_cndmask_b32 v15, 0, v11, s[70:71]
  v_perm_b32 v20, v142, v138, s61
  v_perm_b32 v21, v150, v146, s61
  v_perm_b32 v22, v158, v154, s61
  v_perm_b32 v23, v166, v162, s61
  v_mfma_f32_16x16x32_bf16 v[4:7], v[12:15], v[16:19], v[4:7]
  v_cndmask_b32 v12, 0, v8, s[72:73]
  v_cndmask_b32 v13, 0, v9, s[72:73]
  v_cndmask_b32 v14, 0, v10, s[72:73]
  v_cndmask_b32 v15, 0, v11, s[72:73]
  v_perm_b32 v16, v143, v139, s60
  v_perm_b32 v17, v151, v147, s60
  v_perm_b32 v18, v159, v155, s60
  v_perm_b32 v19, v167, v163, s60
  v_mfma_f32_16x16x32_bf16 v[4:7], v[12:15], v[20:23], v[4:7]
  v_cndmask_b32 v12, 0, v8, s[74:75]
  v_cndmask_b32 v13, 0, v9, s[74:75]
  v_cndmask_b32 v14, 0, v10, s[74:75]
  v_cndmask_b32 v15, 0, v11, s[74:75]
  v_perm_b32 v20, v143, v139, s61
  v_perm_b32 v21, v151, v147, s61
  v_perm_b32 v22, v159, v155, s61
  v_perm_b32 v23, v167, v163, s61
  s_add_u32 s46, s45, 4096
  buffer_load_dwordx4 v[136:139], v1, s[40:43], s45 offen offset:0 nt
  buffer_load_dwordx4 v[140:143], v1, s[40:43], s45 offen offset:256 nt
  buffer_load_dwordx4 v[144:147], v1, s[40:43], s45 offen offset:512 nt
  buffer_load_dwordx4 v[148:151], v1, s[40:43], s45 offen offset:768 nt
  buffer_load_dwordx4 v[152:155], v1, s[40:43], s46 offen offset:0 nt
  buffer_load_dwordx4 v[156:159], v1, s[40:43], s46 offen offset:256 nt
  buffer_load_dwordx4 v[160:163], v1, s[40:43], s46 offen offset:512 nt
  buffer_load_dwordx4 v[164:167], v1, s[40:43], s46 offen offset:768 nt
  v_mfma_f32_16x16x32_bf16 v[4:7], v[12:15], v[16:19], v[4:7]
  v_cndmask_b32 v12, 0, v8, s[76:77]
  v_cndmask_b32 v13, 0, v9, s[76:77]
  v_cndmask_b32 v14, 0, v10, s[76:77]
  v_cndmask_b32 v15, 0, v11, s[76:77]
  s_nop 1
  v_mfma_f32_16x16x32_bf16 v[4:7], v[12:15], v[20:23], v[4:7]
  s_waitcnt lgkmcnt(0)
  v_mfma_f32_16x16x32_bf16 v[8:11], v[40:43], v[24:27], 0
  v_mfma_f32_16x16x32_bf16 v[12:15], v[56:59], v[24:27], 0
  v_readfirstlane_b32 s44, v3
  v_mfma_f32_16x16x32_bf16 v[8:11], v[44:47], v[28:31], v[8:11]
  v_mfma_f32_16x16x32_bf16 v[12:15], v[60:63], v[28:31], v[12:15]
  v_mfma_f32_16x16x32_bf16 v[8:11], v[48:51], v[32:35], v[8:11]
  v_mfma_f32_16x16x32_bf16 v[12:15], v[64:67], v[32:35], v[12:15]
  v_mfma_f32_16x16x32_bf16 v[8:11], v[52:55], v[36:39], v[8:11]
  v_mfma_f32_16x16x32_bf16 v[12:15], v[68:71], v[36:39], v[12:15]
  s_lshl_b32 s44, s44, 13
  s_add_u32 s46, s44, 4096
  buffer_load_dwordx4 v[40:43], v0, s[36:39], s44 offen offset:0 nt
  buffer_load_dwordx4 v[44:47], v0, s[36:39], s44 offen offset:64 nt
  buffer_load_dwordx4 v[48:51], v0, s[36:39], s44 offen offset:128 nt
  buffer_load_dwordx4 v[52:55], v0, s[36:39], s44 offen offset:192 nt
  buffer_load_dwordx4 v[56:59], v0, s[36:39], s46 offen offset:0 nt
  buffer_load_dwordx4 v[60:63], v0, s[36:39], s46 offen offset:64 nt
  buffer_load_dwordx4 v[64:67], v0, s[36:39], s46 offen offset:128 nt
  buffer_load_dwordx4 v[68:71], v0, s[36:39], s46 offen offset:192 nt
  v_mov_b32 v16, 16656
  v_mov_b32 v17, 1
  s_mov_b64 exec, 1
  ds_add_rtn_u32 v3, v16, v17
  s_mov_b64 exec, -1
  v_max3_f32 v17, v8, v9, v10
  v_max3_f32 v17, v17, v11, v12
  v_max3_f32 v17, v17, v13, v14
  v_max_f32 v17, v17, v15
  v_cmp_lt_f32 vcc, s48, v17
  s_cbranch_vccnz L_RAREc
L_CONTc:
  v_mov_b32 v16, s49
  v_fma_f32 v8, v8, s52, v16
  v_fma_f32 v9, v9, s52, v16
  v_fma_f32 v10, v10, s52, v16
  v_fma_f32 v11, v11, s52, v16
  v_fma_f32 v12, v12, s52, v16
  v_fma_f32 v13, v13, s52, v16
  v_fma_f32 v14, v14, s52, v16
  v_fma_f32 v15, v15, s52, v16
  v_exp_f32 v8, v8
  v_exp_f32 v9, v9
  v_exp_f32 v10, v10
  v_exp_f32 v11, v11
  v_exp_f32 v12, v12
  v_exp_f32 v13, v13
  v_exp_f32 v14, v14
  v_exp_f32 v15, v15
  v_cvt_pk_bf16_f32 v8, v8, v9
  v_cvt_pk_bf16_f32 v9, v10, v11
  v_cvt_pk_bf16_f32 v10, v12, v13
  v_cvt_pk_bf16_f32 v11, v14, v15
  v_perm_b32 v16, v76, v72, s60
  v_perm_b32 v17, v84, v80, s60
  v_perm_b32 v18, v92, v88, s60
  v_perm_b32 v19, v100, v96, s60
  v_dot2_f32_bf16 v2, v8, s53, v2
  v_dot2_f32_bf16 v2, v9, s53, v2
  v_dot2_f32_bf16 v2, v10, s53, v2
  v_dot2_f32_bf16 v2, v11, s53, v2
  v_cndmask_b32 v12, 0, v8, s[62:63]
  v_cndmask_b32 v13, 0, v9, s[62:63]
  v_cndmask_b32 v14, 0, v10, s[62:63]
  v_cndmask_b32 v15, 0, v11, s[62:63]
  v_perm_b32 v20, v76, v72, s61
  v_perm_b32 v21, v84, v80, s61
  v_perm_b32 v22, v92, v88, s61
  v_perm_b32 v23, v100, v96, s61
  v_mfma_f32_16x16x32_bf16 v[4:7], v[12:15], v[16:19], v[4:7]
  v_cndmask_b32 v12, 0, v8, s[64:65]
  v_cndmask_b32 v13, 0, v9, s[64:65]
  v_cndmask_b32 v14, 0, v10, s[64:65]
  v_cndmask_b32 v15, 0, v11, s[64:65]
  v_perm_b32 v16, v77, v73, s60
  v_perm_b32 v17, v85, v81, s60
  v_perm_b32 v18, v93, v89, s60
  v_perm_b32 v19, v101, v97, s60
  v_mfma_f32_16x16x32_bf16 v[4:7], v[12:15], v[20:23], v[4:7]
  v_cndmask_b32 v12, 0, v8, s[66:67]
  v_cndmask_b32 v13, 0, v9, s[66:67]
  v_cndmask_b32 v14, 0, v10, s[66:67]
  v_cndmask_b32 v15, 0, v11, s[66:67]
  v_perm_b32 v20, v77, v73, s61
  v_perm_b32 v21, v85, v81, s61
  v_perm_b32 v22, v93, v89, s61
  v_perm_b32 v23, v101, v97, s61
  v_mfma_f32_16x16x32_bf16 v[4:7], v[12:15], v[16:19], v[4:7]
  v_cndmask_b32 v12, 0, v8, s[68:69]
  v_cndmask_b32 v13, 0, v9, s[68:69]
  v_cndmask_b32 v14, 0, v10, s[68:69]
  v_cndmask_b32 v15, 0, v11, s[68:69]
  v_perm_b32 v16, v78, v74, s60
  v_perm_b32 v17, v86, v82, s60
  v_perm_b32 v18, v94, v90, s60
  v_perm_b32 v19, v102, v98, s60
  v_mfma_f32_16x16x32_bf16 v[4:7], v[12:15], v[20:23], v[4:7]
  v_cndmask_b32 v12, 0, v8, s[70:71]
  v_cndmask_b32 v13, 0, v9, s[70:71]
  v_cndmask_b32 v14, 0, v10, s[70:71]
  v_cndmask_b32 v15, 0, v11, s[70:71]
  v_perm_b32 v20, v78, v74, s61
  v_perm_b32 v21, v86, v82, s61
  v_perm_b32 v22, v94, v90, s61
  v_perm_b32 v23, v102, v98, s61
  v_mfma_f32_16x16x32_bf16 v[4:7], v[12:15], v[16:19], v[4:7]
  v_cndmask_b32 v12, 0, v8, s[72:73]
  v_cndmask_b32 v13, 0, v9, s[72:73]
  v_cndmask_b32 v14, 0, v10, s[72:73]
  v_cndmask_b32 v15, 0, v11, s[72:73]
  v_perm_b32 v16, v79, v75, s60
  v_perm_b32 v17, v87, v83, s60
  v_perm_b32 v18, v95, v91, s60
  v_perm_b32 v19, v103, v99, s60
  v_mfma_f32_16x16x32_bf16 v[4:7], v[12:15], v[20:23], v[4:7]
  v_cndmask_b32 v12, 0, v8, s[74:75]
  v_cndmask_b32 v13, 0, v9, s[74:75]
  v_cndmask_b32 v14, 0, v10, s[74:75]
  v_cndmask_b32 v15, 0, v11, s[74:75]
  v_perm_b32 v20, v79, v75, s61
  v_perm_b32 v21, v87, v83, s61
  v_perm_b32 v22, v95, v91, s61
  v_perm_b32 v23, v103, v99, s61
  s_add_u32 s46, s44, 4096
  buffer_load_dwordx4 v[72:75], v1, s[40:43], s44 offen offset:0 nt
  buffer_load_dwordx4 v[76:79], v1, s[40:43], s44 offen offset:256 nt
  buffer_load_dwordx4 v[80:83], v1, s[40:43], s44 offen offset:512 nt
  buffer_load_dwordx4 v[84:87], v1, s[40:43], s44 offen offset:768 nt
  buffer_load_dwordx4 v[88:91], v1, s[40:43], s46 offen offset:0 nt
  buffer_load_dwordx4 v[92:95], v1, s[40:43], s46 offen offset:256 nt
  buffer_load_dwordx4 v[96:99], v1, s[40:43], s46 offen offset:512 nt
  buffer_load_dwordx4 v[100:103], v1, s[40:43], s46 offen offset:768 nt
  v_mfma_f32_16x16x32_bf16 v[4:7], v[12:15], v[16:19], v[4:7]
  v_cndmask_b32 v12, 0, v8, s[76:77]
  v_cndmask_b32 v13, 0, v9, s[76:77]
  v_cndmask_b32 v14, 0, v10, s[76:77]
  v_cndmask_b32 v15, 0, v11, s[76:77]
  s_nop 1
  v_mfma_f32_16x16x32_bf16 v[4:7], v[12:15], v[20:23], v[4:7]
L_LOOP:
  s_cmp_ge_u32 s45, 0x100000
  s_cbranch_scc1 L_LOOPEND
  s_waitcnt vmcnt(24) lgkmcnt(0)
  v_mfma_f32_16x16x32_bf16 v[8:11], v[104:107], v[24:27], 0
  v_mfma_f32_16x16x32_bf16 v[12:15], v[120:123], v[24:27], 0
  v_readfirstlane_b32 s45, v3
  v_mfma_f32_16x16x32_bf16 v[8:11], v[108:111], v[28:31], v[8:11]
  v_mfma_f32_16x16x32_bf16 v[12:15], v[124:127], v[28:31], v[12:15]
  v_mfma_f32_16x16x32_bf16 v[8:11], v[112:115], v[32:35], v[8:11]
  v_mfma_f32_16x16x32_bf16 v[12:15], v[128:131], v[32:35], v[12:15]
  v_mfma_f32_16x16x32_bf16 v[8:11], v[116:119], v[36:39], v[8:11]
  v_mfma_f32_16x16x32_bf16 v[12:15], v[132:135], v[36:39], v[12:15]
  s_lshl_b32 s45, s45, 13
  s_add_u32 s46, s45, 4096
  buffer_load_dwordx4 v[104:107], v0, s[36:39], s45 offen offset:0 nt
  buffer_load_dwordx4 v[108:111], v0, s[36:39], s45 offen offset:64 nt
  buffer_load_dwordx4 v[112:115], v0, s[36:39], s45 offen offset:128 nt
  buffer_load_dwordx4 v[116:119], v0, s[36:39], s45 offen offset:192 nt
  buffer_load_dwordx4 v[120:123], v0, s[36:39], s46 offen offset:0 nt
  buffer_load_dwordx4 v[124:127], v0, s[36:39], s46 offen offset:64 nt
  buffer_load_dwordx4 v[128:131], v0, s[36:39], s46 offen offset:128 nt
  buffer_load_dwordx4 v[132:135], v0, s[36:39], s46 offen offset:192 nt
  v_mov_b32 v16, 16656
  v_mov_b32 v17, 1
  s_mov_b64 exec, 1
  ds_add_rtn_u32 v3, v16, v17
  s_mov_b64 exec, -1
  v_max3_f32 v17, v8, v9, v10
  v_max3_f32 v17, v17, v11, v12
  v_max3_f32 v17, v17, v13, v14
  v_max_f32 v17, v17, v15
  v_cmp_lt_f32 vcc, s48, v17
  s_cbranch_vccnz L_RARE1
L_CONT1:
  v_mov_b32 v16, s49
  v_fma_f32 v8, v8, s52, v16
  v_fma_f32 v9, v9, s52, v16
  v_fma_f32 v10, v10, s52, v16
  v_fma_f32 v11, v11, s52, v16
  v_fma_f32 v12, v12, s52, v16
  v_fma_f32 v13, v13, s52, v16
  v_fma_f32 v14, v14, s52, v16
  v_fma_f32 v15, v15, s52, v16
  v_exp_f32 v8, v8
  v_exp_f32 v9, v9
  v_exp_f32 v10, v10
  v_exp_f32 v11, v11
  v_exp_f32 v12, v12
  v_exp_f32 v13, v13
  v_exp_f32 v14, v14
  v_exp_f32 v15, v15
  v_cvt_pk_bf16_f32 v8, v8, v9
  v_cvt_pk_bf16_f32 v9, v10, v11
  v_cvt_pk_bf16_f32 v10, v12, v13
  v_cvt_pk_bf16_f32 v11, v14, v15
  s_waitcnt vmcnt(24)
  v_perm_b32 v16, v140, v136, s60
  v_perm_b32 v17, v148, v144, s60
  v_perm_b32 v18, v156, v152, s60
  v_perm_b32 v19, v164, v160, s60
  v_dot2_f32_bf16 v2, v8, s53, v2
  v_dot2_f32_bf16 v2, v9, s53, v2
  v_dot2_f32_bf16 v2, v10, s53, v2
  v_dot2_f32_bf16 v2, v11, s53, v2
  v_cndmask_b32 v12, 0, v8, s[62:63]
  v_cndmask_b32 v13, 0, v9, s[62:63]
  v_cndmask_b32 v14, 0, v10, s[62:63]
  v_cndmask_b32 v15, 0, v11, s[62:63]
  v_perm_b32 v20, v140, v136, s61
  v_perm_b32 v21, v148, v144, s61
  v_perm_b32 v22, v156, v152, s61
  v_perm_b32 v23, v164, v160, s61
  v_mfma_f32_16x16x32_bf16 v[4:7], v[12:15], v[16:19], v[4:7]
  v_cndmask_b32 v12, 0, v8, s[64:65]
  v_cndmask_b32 v13, 0, v9, s[64:65]
  v_cndmask_b32 v14, 0, v10, s[64:65]
  v_cndmask_b32 v15, 0, v11, s[64:65]
  v_perm_b32 v16, v141, v137, s60
  v_perm_b32 v17, v149, v145, s60
  v_perm_b32 v18, v157, v153, s60
  v_perm_b32 v19, v165, v161, s60
  v_mfma_f32_16x16x32_bf16 v[4:7], v[12:15], v[20:23], v[4:7]
  v_cndmask_b32 v12, 0, v8, s[66:67]
  v_cndmask_b32 v13, 0, v9, s[66:67]
  v_cndmask_b32 v14, 0, v10, s[66:67]
  v_cndmask_b32 v15, 0, v11, s[66:67]
  v_perm_b32 v20, v141, v137, s61
  v_perm_b32 v21, v149, v145, s61
  v_perm_b32 v22, v157, v153, s61
  v_perm_b32 v23, v165, v161, s61
  v_mfma_f32_16x16x32_bf16 v[4:7], v[12:15], v[16:19], v[4:7]
  v_cndmask_b32 v12, 0, v8, s[68:69]
  v_cndmask_b32 v13, 0, v9, s[68:69]
  v_cndmask_b32 v14, 0, v10, s[68:69]
  v_cndmask_b32 v15, 0, v11, s[68:69]
  v_perm_b32 v16, v142, v138, s60
  v_perm_b32 v17, v150, v146, s60
  v_perm_b32 v18, v158, v154, s60
  v_perm_b32 v19, v166, v162, s60
  v_mfma_f32_16x16x32_bf16 v[4:7], v[12:15], v[20:23], v[4:7]
  v_cndmask_b32 v12, 0, v8, s[70:71]
  v_cndmask_b32 v13, 0, v9, s[70:71]
  v_cndmask_b32 v14, 0, v10, s[70:71]
  v_cndmask_b32 v15, 0, v11, s[70:71]
  v_perm_b32 v20, v142, v138, s61
  v_perm_b32 v21, v150, v146, s61
  v_perm_b32 v22, v158, v154, s61
  v_perm_b32 v23, v166, v162, s61
  v_mfma_f32_16x16x32_bf16 v[4:7], v[12:15], v[16:19], v[4:7]
  v_cndmask_b32 v12, 0, v8, s[72:73]
  v_cndmask_b32 v13, 0, v9, s[72:73]
  v_cndmask_b32 v14, 0, v10, s[72:73]
  v_cndmask_b32 v15, 0, v11, s[72:73]
  v_perm_b32 v16, v143, v139, s60
  v_perm_b32 v17, v151, v147, s60
  v_perm_b32 v18, v159, v155, s60
  v_perm_b32 v19, v167, v163, s60
  v_mfma_f32_16x16x32_bf16 v[4:7], v[12:15], v[20:23], v[4:7]
  v_cndmask_b32 v12, 0, v8, s[74:75]
  v_cndmask_b32 v13, 0, v9, s[74:75]
  v_cndmask_b32 v14, 0, v10, s[74:75]
  v_cndmask_b32 v15, 0, v11, s[74:75]
  v_perm_b32 v20, v143, v139, s61
  v_perm_b32 v21, v151, v147, s61
  v_perm_b32 v22, v159, v155, s61
  v_perm_b32 v23, v167, v163, s61
  s_add_u32 s46, s45, 4096
  buffer_load_dwordx4 v[136:139], v1, s[40:43], s45 offen offset:0 nt
  buffer_load_dwordx4 v[140:143], v1, s[40:43], s45 offen offset:256 nt
  buffer_load_dwordx4 v[144:147], v1, s[40:43], s45 offen offset:512 nt
  buffer_load_dwordx4 v[148:151], v1, s[40:43], s45 offen offset:768 nt
  buffer_load_dwordx4 v[152:155], v1, s[40:43], s46 offen offset:0 nt
  buffer_load_dwordx4 v[156:159], v1, s[40:43], s46 offen offset:256 nt
  buffer_load_dwordx4 v[160:163], v1, s[40:43], s46 offen offset:512 nt
  buffer_load_dwordx4 v[164:167], v1, s[40:43], s46 offen offset:768 nt
  v_mfma_f32_16x16x32_bf16 v[4:7], v[12:15], v[16:19], v[4:7]
  v_cndmask_b32 v12, 0, v8, s[76:77]
  v_cndmask_b32 v13, 0, v9, s[76:77]
  v_cndmask_b32 v14, 0, v10, s[76:77]
  v_cndmask_b32 v15, 0, v11, s[76:77]
  s_nop 1
  v_mfma_f32_16x16x32_bf16 v[4:7], v[12:15], v[20:23], v[4:7]
  s_cmp_ge_u32 s44, 0x100000
  s_cbranch_scc1 L_LOOPEND
  s_waitcnt vmcnt(24) lgkmcnt(0)
  v_mfma_f32_16x16x32_bf16 v[8:11], v[40:43], v[24:27], 0
  v_mfma_f32_16x16x32_bf16 v[12:15], v[56:59], v[24:27], 0
  v_readfirstlane_b32 s44, v3
  v_mfma_f32_16x16x32_bf16 v[8:11], v[44:47], v[28:31], v[8:11]
  v_mfma_f32_16x16x32_bf16 v[12:15], v[60:63], v[28:31], v[12:15]
  v_mfma_f32_16x16x32_bf16 v[8:11], v[48:51], v[32:35], v[8:11]
  v_mfma_f32_16x16x32_bf16 v[12:15], v[64:67], v[32:35], v[12:15]
  v_mfma_f32_16x16x32_bf16 v[8:11], v[52:55], v[36:39], v[8:11]
  v_mfma_f32_16x16x32_bf16 v[12:15], v[68:71], v[36:39], v[12:15]
  s_lshl_b32 s44, s44, 13
  s_add_u32 s46, s44, 4096
  buffer_load_dwordx4 v[40:43], v0, s[36:39], s44 offen offset:0 nt
  buffer_load_dwordx4 v[44:47], v0, s[36:39], s44 offen offset:64 nt
  buffer_load_dwordx4 v[48:51], v0, s[36:39], s44 offen offset:128 nt
  buffer_load_dwordx4 v[52:55], v0, s[36:39], s44 offen offset:192 nt
  buffer_load_dwordx4 v[56:59], v0, s[36:39], s46 offen offset:0 nt
  buffer_load_dwordx4 v[60:63], v0, s[36:39], s46 offen offset:64 nt
  buffer_load_dwordx4 v[64:67], v0, s[36:39], s46 offen offset:128 nt
  buffer_load_dwordx4 v[68:71], v0, s[36:39], s46 offen offset:192 nt
  v_mov_b32 v16, 16656
  v_mov_b32 v17, 1
  s_mov_b64 exec, 1
  ds_add_rtn_u32 v3, v16, v17
  s_mov_b64 exec, -1
  v_max3_f32 v17, v8, v9, v10
  v_max3_f32 v17, v17, v11, v12
  v_max3_f32 v17, v17, v13, v14
  v_max_f32 v17, v17, v15
  v_cmp_lt_f32 vcc, s48, v17
  s_cbranch_vccnz L_RARE0
L_CONT0:
  v_mov_b32 v16, s49
  v_fma_f32 v8, v8, s52, v16
  v_fma_f32 v9, v9, s52, v16
  v_fma_f32 v10, v10, s52, v16
  v_fma_f32 v11, v11, s52, v16
  v_fma_f32 v12, v12, s52, v16
  v_fma_f32 v13, v13, s52, v16
  v_fma_f32 v14, v14, s52, v16
  v_fma_f32 v15, v15, s52, v16
  v_exp_f32 v8, v8
  v_exp_f32 v9, v9
  v_exp_f32 v10, v10
  v_exp_f32 v11, v11
  v_exp_f32 v12, v12
  v_exp_f32 v13, v13
  v_exp_f32 v14, v14
  v_exp_f32 v15, v15
  v_cvt_pk_bf16_f32 v8, v8, v9
  v_cvt_pk_bf16_f32 v9, v10, v11
  v_cvt_pk_bf16_f32 v10, v12, v13
  v_cvt_pk_bf16_f32 v11, v14, v15
  s_waitcnt vmcnt(24)
  v_perm_b32 v16, v76, v72, s60
  v_perm_b32 v17, v84, v80, s60
  v_perm_b32 v18, v92, v88, s60
  v_perm_b32 v19, v100, v96, s60
  v_dot2_f32_bf16 v2, v8, s53, v2
  v_dot2_f32_bf16 v2, v9, s53, v2
  v_dot2_f32_bf16 v2, v10, s53, v2
  v_dot2_f32_bf16 v2, v11, s53, v2
  v_cndmask_b32 v12, 0, v8, s[62:63]
  v_cndmask_b32 v13, 0, v9, s[62:63]
  v_cndmask_b32 v14, 0, v10, s[62:63]
  v_cndmask_b32 v15, 0, v11, s[62:63]
  v_perm_b32 v20, v76, v72, s61
  v_perm_b32 v21, v84, v80, s61
  v_perm_b32 v22, v92, v88, s61
  v_perm_b32 v23, v100, v96, s61
  v_mfma_f32_16x16x32_bf16 v[4:7], v[12:15], v[16:19], v[4:7]
  v_cndmask_b32 v12, 0, v8, s[64:65]
  v_cndmask_b32 v13, 0, v9, s[64:65]
  v_cndmask_b32 v14, 0, v10, s[64:65]
  v_cndmask_b32 v15, 0, v11, s[64:65]
  v_perm_b32 v16, v77, v73, s60
  v_perm_b32 v17, v85, v81, s60
  v_perm_b32 v18, v93, v89, s60
  v_perm_b32 v19, v101, v97, s60
  v_mfma_f32_16x16x32_bf16 v[4:7], v[12:15], v[20:23], v[4:7]
  v_cndmask_b32 v12, 0, v8, s[66:67]
  v_cndmask_b32 v13, 0, v9, s[66:67]
  v_cndmask_b32 v14, 0, v10, s[66:67]
  v_cndmask_b32 v15, 0, v11, s[66:67]
  v_perm_b32 v20, v77, v73, s61
  v_perm_b32 v21, v85, v81, s61
  v_perm_b32 v22, v93, v89, s61
  v_perm_b32 v23, v101, v97, s61
  v_mfma_f32_16x16x32_bf16 v[4:7], v[12:15], v[16:19], v[4:7]
  v_cndmask_b32 v12, 0, v8, s[68:69]
  v_cndmask_b32 v13, 0, v9, s[68:69]
  v_cndmask_b32 v14, 0, v10, s[68:69]
  v_cndmask_b32 v15, 0, v11, s[68:69]
  v_perm_b32 v16, v78, v74, s60
  v_perm_b32 v17, v86, v82, s60
  v_perm_b32 v18, v94, v90, s60
  v_perm_b32 v19, v102, v98, s60
  v_mfma_f32_16x16x32_bf16 v[4:7], v[12:15], v[20:23], v[4:7]
  v_cndmask_b32 v12, 0, v8, s[70:71]
  v_cndmask_b32 v13, 0, v9, s[70:71]
  v_cndmask_b32 v14, 0, v10, s[70:71]
  v_cndmask_b32 v15, 0, v11, s[70:71]
  v_perm_b32 v20, v78, v74, s61
  v_perm_b32 v21, v86, v82, s61
  v_perm_b32 v22, v94, v90, s61
  v_perm_b32 v23, v102, v98, s61
  v_mfma_f32_16x16x32_bf16 v[4:7], v[12:15], v[16:19], v[4:7]
  v_cndmask_b32 v12, 0, v8, s[72:73]
  v_cndmask_b32 v13, 0, v9, s[72:73]
  v_cndmask_b32 v14, 0, v10, s[72:73]
  v_cndmask_b32 v15, 0, v11, s[72:73]
  v_perm_b32 v16, v79, v75, s60
  v_perm_b32 v17, v87, v83, s60
  v_perm_b32 v18, v95, v91, s60
  v_perm_b32 v19, v103, v99, s60
  v_mfma_f32_16x16x32_bf16 v[4:7], v[12:15], v[20:23], v[4:7]
  v_cndmask_b32 v12, 0, v8, s[74:75]
  v_cndmask_b32 v13, 0, v9, s[74:75]
  v_cndmask_b32 v14, 0, v10, s[74:75]
  v_cndmask_b32 v15, 0, v11, s[74:75]
  v_perm_b32 v20, v79, v75, s61
  v_perm_b32 v21, v87, v83, s61
  v_perm_b32 v22, v95, v91, s61
  v_perm_b32 v23, v103, v99, s61
  s_add_u32 s46, s44, 4096
  buffer_load_dwordx4 v[72:75], v1, s[40:43], s44 offen offset:0 nt
  buffer_load_dwordx4 v[76:79], v1, s[40:43], s44 offen offset:256 nt
  buffer_load_dwordx4 v[80:83], v1, s[40:43], s44 offen offset:512 nt
  buffer_load_dwordx4 v[84:87], v1, s[40:43], s44 offen offset:768 nt
  buffer_load_dwordx4 v[88:91], v1, s[40:43], s46 offen offset:0 nt
  buffer_load_dwordx4 v[92:95], v1, s[40:43], s46 offen offset:256 nt
  buffer_load_dwordx4 v[96:99], v1, s[40:43], s46 offen offset:512 nt
  buffer_load_dwordx4 v[100:103], v1, s[40:43], s46 offen offset:768 nt
  v_mfma_f32_16x16x32_bf16 v[4:7], v[12:15], v[16:19], v[4:7]
  v_cndmask_b32 v12, 0, v8, s[76:77]
  v_cndmask_b32 v13, 0, v9, s[76:77]
  v_cndmask_b32 v14, 0, v10, s[76:77]
  v_cndmask_b32 v15, 0, v11, s[76:77]
  s_nop 1
  v_mfma_f32_16x16x32_bf16 v[4:7], v[12:15], v[20:23], v[4:7]
  s_branch L_LOOP
L_LOOPEND:
  s_waitcnt lgkmcnt(0)
  s_nop 7
  s_nop 3
  v_mbcnt_lo_u32_b32 v3, -1, 0
  v_mbcnt_hi_u32_b32 v3, -1, v3
  v_mov_b32 v17, v2
  s_nop 1
  v_permlane16_swap_b32 v2, v17
  s_nop 1
  v_add_f32 v2, v2, v17
  v_mov_b32 v17, v2
  s_nop 1
  v_permlane32_swap_b32 v2, v17
  s_nop 1
  v_add_f32 v19, v2, v17
  v_mov_b32 v18, s48
  v_and_b32 v16, 15, v3
  v_lshlrev_b32 v16, 5, v16
  v_lshrrev_b32 v17, 4, v3
  v_lshl_add_u32 v16, v17, 4, v16
  s_lshl_b32 s56, s3, 9
  v_add_u32 v16, s56, v16
  s_lshl_b32 s56, s3, 3
  v_mov_b32 v17, s56
  s_mov_b32 exec_hi, 0
  ds_write_b128 v16, v[4:7] offset:16704
  ds_write_b64 v17, v[18:19] offset:20800
  s_mov_b32 exec_hi, -1
  s_waitcnt lgkmcnt(0)
  s_barrier
  s_sub_u32 s56, s2, 184
  s_cmp_ge_u32 s56, 27
  s_cbranch_scc1 L_END
  s_waitcnt vmcnt(0)
  v_mov_b32 v0, v3
  v_lshrrev_b32 v1, 4, v0
  v_and_b32 v2, 15, v0
  v_and_b32 v3, 7, v2
  s_add_u32 s68, s3, 4
  s_mov_b32 s30, 0
  s_mov_b32 s36, s6
  s_mov_b32 s37, s7
  s_mov_b32 s38, 1048576
  s_mov_b32 s39, 0x20000
  v_mov_b32 v6, 0
  ds_read_b32 v7, v6 offset:16660
  s_waitcnt lgkmcnt(0)
  v_readfirstlane_b32 s31, v7
  s_mov_b32 s60, 0x05040100
  s_mov_b32 s61, 0x07060302
  s_cmp_ge_u32 s68, 10
  s_cbranch_scc1 Lnp_78
  s_sub_u32 s57, s2, 184
  s_lshl_b32 s56, s57, 7
  s_add_u32 s44, s20, s56
  s_addc_u32 s45, s21, 0
  s_sub_u32 s46, 2211840, s56
  s_mov_b32 s47, 0x20000
  s_mov_b32 s57, 27648
  v_mul_lo_u32 v5, v1, s57
  v_lshl_add_u32 v5, v2, 3, v5
  s_mul_i32 s56, s68, 221184
  buffer_load_dwordx2 v[8:9], v5, s[44:47], s56 offen nt
  s_add_u32 s56, s56, 3456
  buffer_load_dwordx2 v[10:11], v5, s[44:47], s56 offen nt
  s_add_u32 s56, s56, 3456
  buffer_load_dwordx2 v[12:13], v5, s[44:47], s56 offen nt
  s_add_u32 s56, s56, 3456
  buffer_load_dwordx2 v[14:15], v5, s[44:47], s56 offen nt
  s_add_u32 s56, s56, 3456
  buffer_load_dwordx2 v[16:17], v5, s[44:47], s56 offen nt
  s_add_u32 s56, s56, 3456
  buffer_load_dwordx2 v[18:19], v5, s[44:47], s56 offen nt
  s_add_u32 s56, s56, 3456
  buffer_load_dwordx2 v[20:21], v5, s[44:47], s56 offen nt
  s_add_u32 s56, s56, 3456
  buffer_load_dwordx2 v[22:23], v5, s[44:47], s56 offen nt
  s_add_u32 s56, s56, 86400
  buffer_load_dwordx2 v[24:25], v5, s[44:47], s56 offen nt
  s_add_u32 s56, s56, 3456
  buffer_load_dwordx2 v[26:27], v5, s[44:47], s56 offen nt
  s_add_u32 s56, s56, 3456
  buffer_load_dwordx2 v[28:29], v5, s[44:47], s56 offen nt
  s_add_u32 s56, s56, 3456
  buffer_load_dwordx2 v[30:31], v5, s[44:47], s56 offen nt
  s_add_u32 s56, s56, 3456
  buffer_load_dwordx2 v[32:33], v5, s[44:47], s56 offen nt
  s_add_u32 s56, s56, 3456
  buffer_load_dwordx2 v[34:35], v5, s[44:47], s56 offen nt
  s_add_u32 s56, s56, 3456
  buffer_load_dwordx2 v[36:37], v5, s[44:47], s56 offen nt
  s_add_u32 s56, s56, 3456
  buffer_load_dwordx2 v[38:39], v5, s[44:47], s56 offen nt
  v_lshrrev_b32 v7, 3, v2
  v_lshlrev_b32 v7, 7, v7
  v_lshl_add_u32 v7, v3, 8, v7
  v_lshl_add_u32 v7, v1, 5, v7
  s_lshl_b32 s56, s68, 11
Lpoll_79:
  s_add_u32 s57, s56, 61440
  buffer_load_dwordx4 v[72:75], v7, s[36:39], s57 offen sc1
  buffer_load_dwordx4 v[76:79], v7, s[36:39], s57 offen offset:16 sc1
  s_add_u32 s57, s56, 81920
  buffer_load_dwordx4 v[80:83], v7, s[36:39], s57 offen sc1
  buffer_load_dwordx4 v[84:87], v7, s[36:39], s57 offen offset:16 sc1
  s_waitcnt vmcnt(0)
  v_cmp_ne_u32 vcc, s31, v73
  v_cmp_ne_u32 s[58:59], s31, v77
  s_or_b64 vcc, vcc, s[58:59]
  v_cmp_ne_u32 s[58:59], s31, v81
  s_or_b64 vcc, vcc, s[58:59]
  v_cmp_ne_u32 s[58:59], s31, v85
  s_or_b64 vcc, vcc, s[58:59]
  s_cbranch_vccz Lpd_80
  s_sleep 100
  s_add_u32 s30, s30, 1
  s_cmp_gt_u32 s30, 400000
  s_cbranch_scc0 Lpoll_79
Lpd_80:
  v_perm_b32 v40, v10, v8, s60
  v_perm_b32 v44, v10, v8, s61
  v_perm_b32 v48, v11, v9, s60
  v_perm_b32 v52, v11, v9, s61
  v_perm_b32 v41, v14, v12, s60
  v_perm_b32 v45, v14, v12, s61
  v_perm_b32 v49, v15, v13, s60
  v_perm_b32 v53, v15, v13, s61
  v_perm_b32 v42, v18, v16, s60
  v_perm_b32 v46, v18, v16, s61
  v_perm_b32 v50, v19, v17, s60
  v_perm_b32 v54, v19, v17, s61
  v_perm_b32 v43, v22, v20, s60
  v_perm_b32 v47, v22, v20, s61
  v_perm_b32 v51, v23, v21, s60
  v_perm_b32 v55, v23, v21, s61
  v_perm_b32 v56, v26, v24, s60
  v_perm_b32 v60, v26, v24, s61
  v_perm_b32 v64, v27, v25, s60
  v_perm_b32 v68, v27, v25, s61
  v_perm_b32 v57, v30, v28, s60
  v_perm_b32 v61, v30, v28, s61
  v_perm_b32 v65, v31, v29, s60
  v_perm_b32 v69, v31, v29, s61
  v_perm_b32 v58, v34, v32, s60
  v_perm_b32 v62, v34, v32, s61
  v_perm_b32 v66, v35, v33, s60
  v_perm_b32 v70, v35, v33, s61
  v_perm_b32 v59, v38, v36, s60
  v_perm_b32 v63, v38, v36, s61
  v_perm_b32 v67, v39, v37, s60
  v_perm_b32 v71, v39, v37, s61
  v_lshlrev_b32 v100, 16, v72
  v_and_b32 v101, 0xffff0000, v72
  v_lshlrev_b32 v108, 16, v80
  v_and_b32 v109, 0xffff0000, v80
  v_add_f32 v108, 1.0, v108
  v_add_f32 v109, 1.0, v109
  v_cvt_pk_bf16_f32 v8, v108, v109
  v_lshlrev_b32 v108, 16, v8
  v_and_b32 v109, 0xffff0000, v8
  v_lshlrev_b32 v102, 16, v74
  v_and_b32 v103, 0xffff0000, v74
  v_lshlrev_b32 v110, 16, v82
  v_and_b32 v111, 0xffff0000, v82
  v_add_f32 v110, 1.0, v110
  v_add_f32 v111, 1.0, v111
  v_cvt_pk_bf16_f32 v8, v110, v111
  v_lshlrev_b32 v110, 16, v8
  v_and_b32 v111, 0xffff0000, v8
  v_lshlrev_b32 v104, 16, v76
  v_and_b32 v105, 0xffff0000, v76
  v_lshlrev_b32 v112, 16, v84
  v_and_b32 v113, 0xffff0000, v84
  v_add_f32 v112, 1.0, v112
  v_add_f32 v113, 1.0, v113
  v_cvt_pk_bf16_f32 v8, v112, v113
  v_lshlrev_b32 v112, 16, v8
  v_and_b32 v113, 0xffff0000, v8
  v_lshlrev_b32 v106, 16, v78
  v_and_b32 v107, 0xffff0000, v78
  v_lshlrev_b32 v114, 16, v86
  v_and_b32 v115, 0xffff0000, v86
  v_add_f32 v114, 1.0, v114
  v_add_f32 v115, 1.0, v115
  v_cvt_pk_bf16_f32 v8, v114, v115
  v_lshlrev_b32 v114, 16, v8
  v_and_b32 v115, 0xffff0000, v8
  v_lshrrev_b32 v4, 3, v2
  v_lshlrev_b32 v4, 9, v4
  v_lshl_add_u32 v4, v3, 6, v4
  v_lshl_add_u32 v4, v1, 4, v4
Lnp_78:
  s_cmp_ge_u32 s68, 10
  s_cbranch_scc1 Le2idle_81
  s_lshl_b32 s56, s68, 10
  s_add_u32 s56, s56, 524288
Lpoll_83:
  buffer_load_dwordx4 v[16:19], v4, s[36:39], s56 offen sc1
  s_waitcnt vmcnt(0)
  v_cmp_eq_u32 vcc, -1, v16
  v_cmp_eq_u32 s[58:59], -1, v17
  s_or_b64 vcc, vcc, s[58:59]
  v_cmp_eq_u32 s[58:59], -1, v18
  s_or_b64 vcc, vcc, s[58:59]
  v_cmp_eq_u32 s[58:59], -1, v19
  s_or_b64 vcc, vcc, s[58:59]
  s_cbranch_vccz Lpd_84
  s_add_u32 s30, s30, 1
  s_cmp_gt_u32 s30, 400000
  s_cbranch_scc0 Lpoll_83
Lpd_84:
  v_lshlrev_b32 v8, 16, v16
  v_and_b32 v9, 0xffff0000, v16
  v_lshlrev_b32 v10, 16, v17
  v_and_b32 v11, 0xffff0000, v17
  v_lshlrev_b32 v12, 16, v18
  v_and_b32 v13, 0xffff0000, v18
  v_lshlrev_b32 v14, 16, v19
  v_and_b32 v15, 0xffff0000, v19
  v_add_f32 v32, v8, v9
  v_mul_f32 v33, v8, v8
  v_fmac_f32 v33, v9, v9
  v_add_f32 v32, v32, v10
  v_fmac_f32 v33, v10, v10
  v_add_f32 v32, v32, v11
  v_fmac_f32 v33, v11, v11
  v_add_f32 v32, v32, v12
  v_fmac_f32 v33, v12, v12
  v_add_f32 v32, v32, v13
  v_fmac_f32 v33, v13, v13
  v_add_f32 v32, v32, v14
  v_fmac_f32 v33, v14, v14
  v_add_f32 v32, v32, v15
  v_fmac_f32 v33, v15, v15
  s_nop 1
  v_add_f32_dpp v32, v32, v32 row_ror:8 row_mask:0xf bank_mask:0xf
  v_mov_b32 v34, v32
  s_nop 1
  v_permlane16_swap_b32 v32, v34
  s_nop 1
  v_add_f32 v32, v32, v34
  v_mov_b32 v34, v32
  s_nop 1
  v_permlane32_swap_b32 v32, v34
  s_nop 1
  v_add_f32 v32, v32, v34
  s_nop 1
  v_add_f32_dpp v33, v33, v33 row_ror:8 row_mask:0xf bank_mask:0xf
  v_mov_b32 v34, v33
  s_nop 1
  v_permlane16_swap_b32 v33, v34
  s_nop 1
  v_add_f32 v33, v33, v34
  v_mov_b32 v34, v33
  s_nop 1
  v_permlane32_swap_b32 v33, v34
  s_nop 1
  v_add_f32 v33, v33, v34
  v_lshlrev_b32 v7, 3, v3
  s_lshl_b32 s56, s68, 6
  v_add_u32 v7, s56, v7
  ds_write_b64 v7, v[32:33] offset:20864
  s_waitcnt lgkmcnt(0)
Le2idle_81:
  s_barrier
  s_cmp_ge_u32 s68, 10
  s_cbranch_scc1 Le2idle_82
  v_lshlrev_b32 v7, 3, v3
  ds_read_b64 v[116:117], v7 offset:20864
  ds_read_b64 v[118:119], v7 offset:20928
  ds_read_b64 v[120:121], v7 offset:20992
  ds_read_b64 v[122:123], v7 offset:21056
  ds_read_b64 v[124:125], v7 offset:21120
  ds_read_b64 v[126:127], v7 offset:21184
  ds_read_b64 v[128:129], v7 offset:21248
  ds_read_b64 v[130:131], v7 offset:21312
  ds_read_b64 v[132:133], v7 offset:21376
  ds_read_b64 v[134:135], v7 offset:21440
  s_waitcnt lgkmcnt(0)
  v_add_f32 v116, v116, v118
  v_add_f32 v117, v117, v119
  v_add_f32 v120, v120, v122
  v_add_f32 v121, v121, v123
  v_add_f32 v124, v124, v126
  v_add_f32 v125, v125, v127
  v_add_f32 v128, v128, v130
  v_add_f32 v129, v129, v131
  v_add_f32 v132, v132, v134
  v_add_f32 v133, v133, v135
  v_add_f32 v116, v116, v120
  v_add_f32 v117, v117, v121
  v_add_f32 v124, v124, v128
  v_add_f32 v125, v125, v129
  v_add_f32 v116, v116, v124
  v_add_f32 v117, v117, v125
  v_add_f32 v32, v116, v132
  v_add_f32 v33, v117, v133
  v_mul_f32 v32, 0x3acccccd, v32
  v_mul_f32 v33, 0x3acccccd, v33
  v_fma_f32 v33, -v32, v32, v33
  v_max_f32 v33, 0, v33
  v_cvt_pk_bf16_f32 v34, v32, v33
  v_lshlrev_b32 v36, 16, v34
  v_and_b32 v33, 0xffff0000, v34
  v_add_f32 v33, 0x3727c5ac, v33
  v_cvt_pk_bf16_f32 v34, v33, v33
  v_lshlrev_b32 v33, 16, v34
  v_sqrt_f32 v33, v33
  s_nop 0
  v_cvt_pk_bf16_f32 v34, v33, v33
  v_lshlrev_b32 v33, 16, v34
  v_rcp_f32 v37, v33
  s_nop 0
  v_sub_f32 v8, v8, v36
  v_sub_f32 v9, v9, v36
  v_cvt_pk_bf16_f32 v34, v8, v9
  v_lshlrev_b32 v8, 16, v34
  v_and_b32 v9, 0xffff0000, v34
  v_mul_f32 v8, v8, v37
  v_mul_f32 v9, v9, v37
  v_cvt_pk_bf16_f32 v34, v8, v9
  v_lshlrev_b32 v8, 16, v34
  v_and_b32 v9, 0xffff0000, v34
  v_mul_f32 v8, v8, v108
  v_mul_f32 v9, v9, v109
  v_cvt_pk_bf16_f32 v34, v8, v9
  v_lshlrev_b32 v8, 16, v34
  v_and_b32 v9, 0xffff0000, v34
  v_add_f32 v8, v8, v100
  v_add_f32 v9, v9, v101
  v_cvt_pk_bf16_f32 v16, v8, v9
  v_sub_f32 v10, v10, v36
  v_sub_f32 v11, v11, v36
  v_cvt_pk_bf16_f32 v34, v10, v11
  v_lshlrev_b32 v10, 16, v34
  v_and_b32 v11, 0xffff0000, v34
  v_mul_f32 v10, v10, v37
  v_mul_f32 v11, v11, v37
  v_cvt_pk_bf16_f32 v34, v10, v11
  v_lshlrev_b32 v10, 16, v34
  v_and_b32 v11, 0xffff0000, v34
  v_mul_f32 v10, v10, v110
  v_mul_f32 v11, v11, v111
  v_cvt_pk_bf16_f32 v34, v10, v11
  v_lshlrev_b32 v10, 16, v34
  v_and_b32 v11, 0xffff0000, v34
  v_add_f32 v10, v10, v102
  v_add_f32 v11, v11, v103
  v_cvt_pk_bf16_f32 v17, v10, v11
  v_sub_f32 v12, v12, v36
  v_sub_f32 v13, v13, v36
  v_cvt_pk_bf16_f32 v34, v12, v13
  v_lshlrev_b32 v12, 16, v34
  v_and_b32 v13, 0xffff0000, v34
  v_mul_f32 v12, v12, v37
  v_mul_f32 v13, v13, v37
  v_cvt_pk_bf16_f32 v34, v12, v13
  v_lshlrev_b32 v12, 16, v34
  v_and_b32 v13, 0xffff0000, v34
  v_mul_f32 v12, v12, v112
  v_mul_f32 v13, v13, v113
  v_cvt_pk_bf16_f32 v34, v12, v13
  v_lshlrev_b32 v12, 16, v34
  v_and_b32 v13, 0xffff0000, v34
  v_add_f32 v12, v12, v104
  v_add_f32 v13, v13, v105
  v_cvt_pk_bf16_f32 v18, v12, v13
  v_sub_f32 v14, v14, v36
  v_sub_f32 v15, v15, v36
  v_cvt_pk_bf16_f32 v34, v14, v15
  v_lshlrev_b32 v14, 16, v34
  v_and_b32 v15, 0xffff0000, v34
  v_mul_f32 v14, v14, v37
  v_mul_f32 v15, v15, v37
  v_cvt_pk_bf16_f32 v34, v14, v15
  v_lshlrev_b32 v14, 16, v34
  v_and_b32 v15, 0xffff0000, v34
  v_mul_f32 v14, v14, v114
  v_mul_f32 v15, v15, v115
  v_cvt_pk_bf16_f32 v34, v14, v15
  v_lshlrev_b32 v14, 16, v34
  v_and_b32 v15, 0xffff0000, v34
  v_add_f32 v14, v14, v106
  v_add_f32 v15, v15, v107
  v_cvt_pk_bf16_f32 v19, v14, v15
  s_nop 1
  v_mfma_f32_16x16x32_bf16 v[116:119], v[16:19], v[40:43], 0
  v_mfma_f32_16x16x32_bf16 v[120:123], v[16:19], v[44:47], 0
  v_mfma_f32_16x16x32_bf16 v[124:127], v[16:19], v[48:51], 0
  v_mfma_f32_16x16x32_bf16 v[128:131], v[16:19], v[52:55], 0
  v_mfma_f32_16x16x32_bf16 v[132:135], v[16:19], v[56:59], 0
  v_mfma_f32_16x16x32_bf16 v[136:139], v[16:19], v[60:63], 0
  v_mfma_f32_16x16x32_bf16 v[140:143], v[16:19], v[64:67], 0
  v_mfma_f32_16x16x32_bf16 v[144:147], v[16:19], v[68:71], 0
  v_lshrrev_b32 v6, 1, v1
  v_lshlrev_b32 v6, 11, v6
  v_and_b32 v7, 1, v1
  v_lshl_add_u32 v6, v7, 10, v6
  v_lshl_add_u32 v6, v2, 4, v6
  s_lshl_b32 s56, s68, 12
  v_add_u32 v6, s56, v6
  s_mov_b32 s58, 0
  s_mov_b32 s59, -1
  s_nop 2
  v_cndmask_b32 v8, v116, v132, s[58:59]
  v_cndmask_b32 v9, v120, v136, s[58:59]
  v_cndmask_b32 v10, v124, v140, s[58:59]
  v_cndmask_b32 v11, v128, v144, s[58:59]
  v_cndmask_b32 v12, v117, v133, s[58:59]
  v_cndmask_b32 v13, v121, v137, s[58:59]
  v_cndmask_b32 v14, v125, v141, s[58:59]
  v_cndmask_b32 v15, v129, v145, s[58:59]
  v_cndmask_b32 v16, v118, v134, s[58:59]
  v_cndmask_b32 v17, v122, v138, s[58:59]
  v_cndmask_b32 v18, v126, v142, s[58:59]
  v_cndmask_b32 v19, v130, v146, s[58:59]
  v_cndmask_b32 v20, v119, v135, s[58:59]
  v_cndmask_b32 v21, v123, v139, s[58:59]
  v_cndmask_b32 v22, v127, v143, s[58:59]
  v_cndmask_b32 v23, v131, v147, s[58:59]
  ds_write_b128 v6, v[8:11] offset:24576
  ds_write_b128 v6, v[12:15] offset:24832
  ds_write_b128 v6, v[16:19] offset:25088
  ds_write_b128 v6, v[20:23] offset:25344
  s_waitcnt lgkmcnt(0)
Le2idle_82:
  s_barrier
  s_cmp_ge_u32 s68, 4
  s_cbranch_scc1 L_END
  v_lshlrev_b32 v6, 3, v0
  s_lshl_b32 s56, s68, 9
  v_add_u32 v6, s56, v6
  ds_read_b64 v[40:41], v6 offset:24576
  ds_read_b64 v[42:43], v6 offset:26624
  ds_read_b64 v[44:45], v6 offset:28672
  ds_read_b64 v[46:47], v6 offset:30720
  ds_read_b64 v[48:49], v6 offset:32768
  ds_read_b64 v[50:51], v6 offset:34816
  ds_read_b64 v[52:53], v6 offset:36864
  ds_read_b64 v[54:55], v6 offset:38912
  ds_read_b64 v[56:57], v6 offset:40960
  ds_read_b64 v[58:59], v6 offset:43008
  ds_read_b64 v[60:61], v6 offset:45056
  ds_read_b64 v[62:63], v6 offset:47104
  ds_read_b64 v[64:65], v6 offset:49152
  ds_read_b64 v[66:67], v6 offset:51200
  ds_read_b64 v[68:69], v6 offset:53248
  ds_read_b64 v[70:71], v6 offset:55296
  ds_read_b64 v[72:73], v6 offset:57344
  ds_read_b64 v[74:75], v6 offset:59392
  ds_read_b64 v[76:77], v6 offset:61440
  ds_read_b64 v[78:79], v6 offset:63488
  s_waitcnt lgkmcnt(0)
  v_add_f32 v40, v40, v42
  v_add_f32 v41, v41, v43
  v_add_f32 v44, v44, v46
  v_add_f32 v45, v45, v47
  v_add_f32 v48, v48, v50
  v_add_f32 v49, v49, v51
  v_add_f32 v52, v52, v54
  v_add_f32 v53, v53, v55
  v_add_f32 v56, v56, v58
  v_add_f32 v57, v57, v59
  v_add_f32 v60, v60, v62
  v_add_f32 v61, v61, v63
  v_add_f32 v64, v64, v66
  v_add_f32 v65, v65, v67
  v_add_f32 v68, v68, v70
  v_add_f32 v69, v69, v71
  v_add_f32 v72, v72, v74
  v_add_f32 v73, v73, v75
  v_add_f32 v76, v76, v78
  v_add_f32 v77, v77, v79
  v_add_f32 v40, v40, v44
  v_add_f32 v41, v41, v45
  v_add_f32 v48, v48, v52
  v_add_f32 v49, v49, v53
  v_add_f32 v56, v56, v60
  v_add_f32 v57, v57, v61
  v_add_f32 v64, v64, v68
  v_add_f32 v65, v65, v69
  v_add_f32 v72, v72, v76
  v_add_f32 v73, v73, v77
  v_add_f32 v40, v40, v48
  v_add_f32 v41, v41, v49
  v_add_f32 v56, v56, v64
  v_add_f32 v57, v57, v65
  v_add_f32 v40, v40, v56
  v_add_f32 v41, v41, v57
  v_add_f32 v40, v40, v72
  v_add_f32 v41, v41, v73
  v_cvt_pk_bf16_f32 v12, v40, v41
  v_lshlrev_b32 v40, 16, v12
  v_and_b32 v41, 0xffff0000, v12
  v_mul_f32 v12, 0xbfb8aa3b, v40
  v_mul_f32 v13, 0xbfb8aa3b, v41
  v_exp_f32 v12, v12
  v_exp_f32 v13, v13
  s_nop 0
  v_add_f32 v12, 1.0, v12
  v_add_f32 v13, 1.0, v13
  v_rcp_f32 v12, v12
  v_rcp_f32 v13, v13
  s_nop 0
  v_mul_f32 v40, v40, v12
  v_mul_f32 v41, v41, v13
  v_cvt_pk_bf16_f32 v8, v40, v41
  v_min_u32 v8, 0xfffeffff, v8
  v_lshlrev_b32 v6, 2, v0
  s_sub_u32 s56, s2, 184
  s_lshl_b32 s56, s56, 10
  s_lshl_b32 s57, s68, 8
  s_add_u32 s56, s56, s57
  s_add_u32 s56, s56, 491520
  buffer_store_dword v8, v6, s[36:39], s56 offen sc1
  s_branch L_END
L_RAREa:
  v_mov_b32 v18, v17
  s_nop 1
  v_permlane16_swap_b32 v17, v18
  s_nop 1
  v_max_f32 v17, v17, v18
  v_mov_b32 v18, v17
  s_nop 1
  v_permlane32_swap_b32 v17, v18
  s_nop 1
  v_max_f32 v17, v17, v18
  v_max_f32 v17, s48, v17
  v_sub_f32 v18, s48, v17
  v_mul_f32 v18, s52, v18
  v_exp_f32 v18, v18
  v_mul_f32 v19, s52, v17
  v_sub_f32 v19, 0, v19
  v_readfirstlane_b32 s48, v17
  v_readfirstlane_b32 s49, v19
  v_mul_f32 v4, v4, v18
  v_mul_f32 v5, v5, v18
  v_mul_f32 v6, v6, v18
  v_mul_f32 v7, v7, v18
  v_mul_f32 v2, v2, v18
  s_nop 1
  s_branch L_CONTa
L_RAREb:
  v_mov_b32 v18, v17
  s_nop 1
  v_permlane16_swap_b32 v17, v18
  s_nop 1
  v_max_f32 v17, v17, v18
  v_mov_b32 v18, v17
  s_nop 1
  v_permlane32_swap_b32 v17, v18
  s_nop 1
  v_max_f32 v17, v17, v18
  v_max_f32 v17, s48, v17
  v_sub_f32 v18, s48, v17
  v_mul_f32 v18, s52, v18
  v_exp_f32 v18, v18
  v_mul_f32 v19, s52, v17
  v_sub_f32 v19, 0, v19
  v_readfirstlane_b32 s48, v17
  v_readfirstlane_b32 s49, v19
  v_mul_f32 v4, v4, v18
  v_mul_f32 v5, v5, v18
  v_mul_f32 v6, v6, v18
  v_mul_f32 v7, v7, v18
  v_mul_f32 v2, v2, v18
  s_nop 1
  s_branch L_CONTb
L_RAREc:
  v_mov_b32 v18, v17
  s_nop 1
  v_permlane16_swap_b32 v17, v18
  s_nop 1
  v_max_f32 v17, v17, v18
  v_mov_b32 v18, v17
  s_nop 1
  v_permlane32_swap_b32 v17, v18
  s_nop 1
  v_max_f32 v17, v17, v18
  v_max_f32 v17, s48, v17
  v_sub_f32 v18, s48, v17
  v_mul_f32 v18, s52, v18
  v_exp_f32 v18, v18
  v_mul_f32 v19, s52, v17
  v_sub_f32 v19, 0, v19
  v_readfirstlane_b32 s48, v17
  v_readfirstlane_b32 s49, v19
  v_mul_f32 v4, v4, v18
  v_mul_f32 v5, v5, v18
  v_mul_f32 v6, v6, v18
  v_mul_f32 v7, v7, v18
  v_mul_f32 v2, v2, v18
  s_nop 1
  s_branch L_CONTc
L_RARE1:
  v_mov_b32 v18, v17
  s_nop 1
  v_permlane16_swap_b32 v17, v18
  s_nop 1
  v_max_f32 v17, v17, v18
  v_mov_b32 v18, v17
  s_nop 1
  v_permlane32_swap_b32 v17, v18
  s_nop 1
  v_max_f32 v17, v17, v18
  v_max_f32 v17, s48, v17
  v_sub_f32 v18, s48, v17
  v_mul_f32 v18, s52, v18
  v_exp_f32 v18, v18
  v_mul_f32 v19, s52, v17
  v_sub_f32 v19, 0, v19
  v_readfirstlane_b32 s48, v17
  v_readfirstlane_b32 s49, v19
  v_mul_f32 v4, v4, v18
  v_mul_f32 v5, v5, v18
  v_mul_f32 v6, v6, v18
  v_mul_f32 v7, v7, v18
  v_mul_f32 v2, v2, v18
  s_nop 1
  s_branch L_CONT1
L_RARE0:
  v_mov_b32 v18, v17
  s_nop 1
  v_permlane16_swap_b32 v17, v18
  s_nop 1
  v_max_f32 v17, v17, v18
  v_mov_b32 v18, v17
  s_nop 1
  v_permlane32_swap_b32 v17, v18
  s_nop 1
  v_max_f32 v17, v17, v18
  v_max_f32 v17, s48, v17
  v_sub_f32 v18, s48, v17
  v_mul_f32 v18, s52, v18
  v_exp_f32 v18, v18
  v_mul_f32 v19, s52, v17
  v_sub_f32 v19, 0, v19
  v_readfirstlane_b32 s48, v17
  v_readfirstlane_b32 s49, v19
  v_mul_f32 v4, v4, v18
  v_mul_f32 v5, v5, v18
  v_mul_f32 v6, v6, v18
  v_mul_f32 v7, v7, v18
  v_mul_f32 v2, v2, v18
  s_nop 1
  s_branch L_CONT0
L_END:
L_EXIT:
  s_endpgm
.section .rodata,"a"
.p2align 6
.amdhsa_kernel adaLN_cond__mha_block_cached__dense_activation_silu__decode_kernel
  .amdhsa_next_free_vgpr 168
  .amdhsa_next_free_sgpr 96
  .amdhsa_accum_offset 168
  .amdhsa_group_segment_fixed_size 0
  .amdhsa_kernarg_size 104
  .amdhsa_user_sgpr_count 2
  .amdhsa_user_sgpr_kernarg_segment_ptr 1
  .amdhsa_system_sgpr_workgroup_id_x 1
.end_amdhsa_kernel
```
